```python
import torch

def _softmax(x, axis=-1):
    return torch.softmax(x, dim=axis)
def _gelu(x):
    return torch.nn.functional.gelu(x, approximate="tanh")
def _silu(x):
    return torch.nn.functional.silu(x)
def _sigmoid(x):
    return torch.sigmoid(x)
def _layernorm(x, axis=-1, eps=1e-5):
    m = x.mean(dim=axis, keepdim=True)
    v = x.var(dim=axis, keepdim=True, unbiased=False)
    return (x - m) / torch.sqrt(v + eps)
def _scatter_add(tgt, idx, src, axis=0):
    return tgt.clone().index_add_(axis, idx, src)
def _segment_sum(src, seg, n):
    out = torch.zeros((n,) + src.shape[1:], dtype=src.dtype)
    return out.index_add_(0, seg, src)
def _pad(x, pw):
    flat = tuple(v for pair in reversed(pw) for v in pair)
    return torch.nn.functional.pad(x, flat)

kernel_name = 'recurrent_scan__compressed_kv_cla__swiglu_ffn__decode'

def setup_inputs():

    _w = (lambda a: (lambda t: t.to(torch.bfloat16) if t.is_floating_point() else t)(torch.as_tensor(a)))
    def _A_setup():
        B, H, Sq, Sk, D, M = 4, 32, 1, 4096, 128, 512
        Dc = 4 * D
        return {
            "x": _w((lambda *s: torch.randn(*s, dtype=torch.bfloat16) * 0.05)(B, Sq, M)),
            "c_kv": _w((lambda *s: torch.randn(*s, dtype=torch.bfloat16) * 0.8)(B, Sk, Dc)),
            "w_q": _w((lambda *s: torch.randn(*s, dtype=torch.bfloat16) * 1.6)(M, H, D) * (M ** -0.5)),
            "w_uk": _w((lambda *s: torch.randn(*s, dtype=torch.bfloat16) * 1.6)(Dc, H, D) * (Dc ** -0.5)),
            "w_uv": _w((lambda *s: torch.randn(*s, dtype=torch.bfloat16) * 0.8)(Dc, H, D) * (Dc ** -0.5)),
            "w_o": _w((lambda *s: torch.randn(*s, dtype=torch.bfloat16) * 0.8)(H, D, M) * ((H * D) ** -0.5)),
        }
    _A_in = _A_setup()

    def _B_setup():
        B, S, D, F = 4, 1, 512, 1792
        return {
            "x": _w((lambda *s: torch.randn(*s, dtype=torch.bfloat16) * 0.05)(B, S, D)),
            "w_gate": _w((lambda *s: torch.randn(*s, dtype=torch.bfloat16) * 0.2)(D, F)),
            "w_up": _w((lambda *s: torch.randn(*s, dtype=torch.bfloat16) * 0.2)(D, F)),
            "w_down": _w((lambda *s: torch.randn(*s, dtype=torch.bfloat16) * 0.2)(F, D)),
        }
    _B_in = _B_setup()

    return {
        "A_x": _A_in["x"],
        "A_c_kv": _A_in["c_kv"],
        "A_w_q": _A_in["w_q"],
        "A_w_uk": _A_in["w_uk"],
        "A_w_uv": _A_in["w_uv"],
        "A_w_o": _A_in["w_o"],
        "B_x": _B_in["x"],
        "B_w_gate": _B_in["w_gate"],
        "B_w_up": _B_in["w_up"],
        "B_w_down": _B_in["w_down"],
    }

def reference(A_x, A_c_kv, A_w_q, A_w_uk, A_w_uv, A_w_o, B_x, B_w_gate, B_w_up, B_w_down):
    def _A_ref(x, c_kv, w_q, w_uk, w_uv, w_o):
        B, Sq, M = x.shape[0], x.shape[1], x.shape[2]
        Sk = c_kv.shape[1]
        H, D = w_q.shape[1], w_q.shape[2]
        q = torch.einsum("bqm,mhd->bhqd", x, w_q)
        k = torch.einsum("bkc,chd->bhkd", c_kv, w_uk)
        v = torch.einsum("bkc,chd->bhkd", c_kv, w_uv)
        scores = torch.einsum("bhqd,bhkd->bhqk", q, k) * (D ** -0.5)
        off = Sk - Sq
        qi = torch.arange(Sq)[:, None]
        kj = torch.arange(Sk)[None, :]
        cmask = kj <= (qi + off)
        scores = torch.where(cmask[None, None], scores, -1e9)
        p = _softmax(scores, axis=-1)
        ctx = torch.einsum("bhqk,bhkd->bhqd", p, v)
        return torch.einsum("bhqd,hdm->bqm", ctx, w_o)

    def _B_ref(x, w_gate, w_up, w_down):
        g = _silu(x @ w_gate)
        u = x @ w_up
        return (g * u) @ w_down

    x = A_x
    xn = _layernorm(x, axis=-1)
    s = _A_ref(xn, A_c_kv, A_w_q, A_w_uk, A_w_uv, A_w_o)
    g = _silu(_B_ref(xn, B_w_gate, B_w_up, B_w_down))
    return x + s * g
```

```asm
; @launch kernel=k1_kernel grid=(368,1,1) block=(256,1,1) lds=14336
; @launch kernel=k2_kernel grid=(256,1,1) block=(512,1,1) lds=156672
; @launch kernel=k3_kernel grid=(312,1,1) block=(256,1,1) lds=20224
; @launch kernel=k4_kernel grid=(64,1,1) block=(256,1,1) lds=1024
.amdgcn_target "amdgcn-amd-amdhsa--gfx950"
.text
.globl k1_kernel
.p2align 8
.type k1_kernel,@function
k1_kernel:
    s_cmp_ge_u32 s2, 368
    s_cbranch_scc1 k1_end
    s_load_dwordx16 s[16:31], s[0:1], 0
    s_load_dwordx8 s[32:39], s[0:1], 64
    s_load_dwordx2 s[40:41], s[0:1], 96
    v_lshrrev_b32 v3, 6, v0
    v_and_b32 v1, 63, v0
    v_readfirstlane_b32 s3, v3
    v_and_b32 v2, 15, v1
    v_lshrrev_b32 v3, 4, v1
    s_mov_b32 s14, 0x05040100
    s_mov_b32 s15, 0x07060302
    s_waitcnt lgkmcnt(0)
    s_mov_b32 s44, s16
    s_and_b32 s45, s17, 0xffff
    s_mov_b32 s46, 0x1000
    s_mov_b32 s47, 0x20000
    s_mov_b32 s56, s40
    s_and_b32 s57, s41, 0xffff
    s_mov_b32 s58, 0x800000
    s_mov_b32 s59, 0x20000
    s_lshl_b32 s4, s3, 10
    v_lshlrev_b32 v4, 4, v1
    v_add_u32 v5, s4, v4
    buffer_load_dwordx4 v[8:11], v5, s[44:47], 0 offen
    s_mul_i32 s4, s3, 1088
    v_add_u32 v6, s4, v4
    s_cmp_ge_u32 s2, 256
    s_cbranch_scc1 k1_ffn
    s_and_b32 s4, s2, 7
    s_lshr_b32 s5, s2, 3
    s_lshr_b32 s6, s5, 3
    s_lshl_b32 s4, s4, 2
    s_add_u32 s6, s6, s4
    s_and_b32 s7, s5, 3
    s_bfe_u32 s13, s5, 0x10002
    s_mov_b32 s48, s20
    s_and_b32 s49, s21, 0xffff
    s_mov_b32 s50, 0x400000
    s_mov_b32 s51, 0x20000
    s_mov_b32 s52, s22
    s_and_b32 s53, s23, 0xffff
    s_mov_b32 s54, 0x400000
    s_mov_b32 s55, 0x20000
    s_lshl_b32 s8, s3, 20
    s_lshl_b32 s9, s6, 8
    s_lshl_b32 s10, s13, 7
    s_add_u32 s9, s9, s10
    s_add_u32 s8, s8, s9
    v_lshrrev_b32 v12, 3, v2
    v_lshl_add_u32 v7, v12, 2, v3
    v_lshlrev_b32 v7, 16, v7
    v_and_b32 v15, 7, v2
    v_lshlrev_b32 v15, 4, v15
    v_add3_u32 v7, v7, v15, s8
    s_mov_b32 s10, 0x0
    buffer_load_dwordx4 v[16:19], v7, s[48:51], s10 offen
    s_mov_b32 s10, 0x2000
    buffer_load_dwordx4 v[20:23], v7, s[48:51], s10 offen
    s_mov_b32 s10, 0x4000
    buffer_load_dwordx4 v[24:27], v7, s[48:51], s10 offen
    s_mov_b32 s10, 0x6000
    buffer_load_dwordx4 v[28:31], v7, s[48:51], s10 offen
    s_mov_b32 s10, 0x8000
    buffer_load_dwordx4 v[32:35], v7, s[48:51], s10 offen
    s_mov_b32 s10, 0xa000
    buffer_load_dwordx4 v[36:39], v7, s[48:51], s10 offen
    s_mov_b32 s10, 0xc000
    buffer_load_dwordx4 v[40:43], v7, s[48:51], s10 offen
    s_mov_b32 s10, 0xe000
    buffer_load_dwordx4 v[44:47], v7, s[48:51], s10 offen
    s_mov_b32 s10, 0x80000
    buffer_load_dwordx4 v[48:51], v7, s[48:51], s10 offen
    s_mov_b32 s10, 0x82000
    buffer_load_dwordx4 v[52:55], v7, s[48:51], s10 offen
    s_mov_b32 s10, 0x84000
    buffer_load_dwordx4 v[56:59], v7, s[48:51], s10 offen
    s_mov_b32 s10, 0x86000
    buffer_load_dwordx4 v[60:63], v7, s[48:51], s10 offen
    s_mov_b32 s10, 0x88000
    buffer_load_dwordx4 v[64:67], v7, s[48:51], s10 offen
    s_mov_b32 s10, 0x8a000
    buffer_load_dwordx4 v[68:71], v7, s[48:51], s10 offen
    s_mov_b32 s10, 0x8c000
    buffer_load_dwordx4 v[72:75], v7, s[48:51], s10 offen
    s_mov_b32 s10, 0x8e000
    buffer_load_dwordx4 v[76:79], v7, s[48:51], s10 offen
    s_lshl_b32 s8, s7, 7
    s_lshl_b32 s10, s3, 5
    s_add_u32 s8, s8, s10
    v_add_u32 v14, s8, v2
    v_lshlrev_b32 v14, 13, v14
    v_lshlrev_b32 v13, 4, v3
    v_add3_u32 v14, v14, v13, s9
    s_mov_b32 s10, 0x20000
    buffer_load_dwordx4 v[144:147], v14, s[52:55], 0 offen offset:0
    buffer_load_dwordx4 v[148:151], v14, s[52:55], 0 offen offset:64
    buffer_load_dwordx4 v[152:155], v14, s[52:55], s10 offen offset:0
    buffer_load_dwordx4 v[156:159], v14, s[52:55], s10 offen offset:64
    s_lshl_b32 s10, s3, 11
    v_lshl_add_u32 v12, v12, 10, v15
    v_add_u32 v12, s10, v12
    s_waitcnt vmcnt(20)
    v_lshlrev_b32 v208, 16, v8
    v_and_b32 v209, 0xffff0000, v8
    v_lshlrev_b32 v210, 16, v9
    v_and_b32 v211, 0xffff0000, v9
    v_lshlrev_b32 v212, 16, v10
    v_and_b32 v213, 0xffff0000, v10
    v_lshlrev_b32 v214, 16, v11
    v_and_b32 v215, 0xffff0000, v11
    v_add_f32 v224, v208, v209
    v_add_f32 v224, v224, v210
    v_add_f32 v224, v224, v211
    v_add_f32 v224, v224, v212
    v_add_f32 v224, v224, v213
    v_add_f32 v224, v224, v214
    v_add_f32 v224, v224, v215
    s_nop 1
    v_add_f32_dpp v225, v224, v224 quad_perm:[1,0,3,2] row_mask:0xf bank_mask:0xf
    s_nop 1
    v_add_f32_dpp v224, v225, v225 quad_perm:[2,3,0,1] row_mask:0xf bank_mask:0xf
    s_nop 1
    v_add_f32_dpp v225, v224, v224 row_half_mirror row_mask:0xf bank_mask:0xf
    s_nop 1
    v_add_f32_dpp v224, v225, v225 row_mirror row_mask:0xf bank_mask:0xf
    v_mov_b32 v225, v224
    s_nop 1
    v_permlane16_swap_b32 v224, v225
    s_nop 0
    v_add_f32 v224, v224, v225
    v_mov_b32 v225, v224
    s_nop 1
    v_permlane32_swap_b32 v224, v225
    s_nop 0
    v_add_f32 v224, v224, v225
    v_mul_f32 v226, 0x3b000000, v224
    v_sub_f32 v216, v208, v226
    v_sub_f32 v217, v209, v226
    v_sub_f32 v218, v210, v226
    v_sub_f32 v219, v211, v226
    v_sub_f32 v220, v212, v226
    v_sub_f32 v221, v213, v226
    v_sub_f32 v222, v214, v226
    v_sub_f32 v223, v215, v226
    v_mul_f32 v224, v216, v216
    v_fma_f32 v224, v217, v217, v224
    v_fma_f32 v224, v218, v218, v224
    v_fma_f32 v224, v219, v219, v224
    v_fma_f32 v224, v220, v220, v224
    v_fma_f32 v224, v221, v221, v224
    v_fma_f32 v224, v222, v222, v224
    v_fma_f32 v224, v223, v223, v224
    s_nop 1
    v_add_f32_dpp v225, v224, v224 quad_perm:[1,0,3,2] row_mask:0xf bank_mask:0xf
    s_nop 1
    v_add_f32_dpp v224, v225, v225 quad_perm:[2,3,0,1] row_mask:0xf bank_mask:0xf
    s_nop 1
    v_add_f32_dpp v225, v224, v224 row_half_mirror row_mask:0xf bank_mask:0xf
    s_nop 1
    v_add_f32_dpp v224, v225, v225 row_mirror row_mask:0xf bank_mask:0xf
    v_mov_b32 v225, v224
    s_nop 1
    v_permlane16_swap_b32 v224, v225
    s_nop 0
    v_add_f32 v224, v224, v225
    v_mov_b32 v225, v224
    s_nop 1
    v_permlane32_swap_b32 v224, v225
    s_nop 0
    v_add_f32 v224, v224, v225
    v_mul_f32 v224, 0x3b000000, v224
    v_cvt_pk_bf16_f32 v227, v224, v226
    v_lshlrev_b32 v228, 16, v227
    v_and_b32 v229, 0xffff0000, v227
    v_add_f32 v228, 0x3727c5ac, v228
    v_cvt_pk_bf16_f32 v227, v228, v228
    v_lshlrev_b32 v228, 16, v227
    v_sqrt_f32 v230, v228
    s_nop 0
    v_cvt_pk_bf16_f32 v227, v230, v230
    v_lshlrev_b32 v230, 16, v227
    v_rcp_f32 v231, v230
    v_sub_f32 v216, v208, v229
    v_sub_f32 v217, v209, v229
    v_sub_f32 v218, v210, v229
    v_sub_f32 v219, v211, v229
    v_sub_f32 v220, v212, v229
    v_sub_f32 v221, v213, v229
    v_sub_f32 v222, v214, v229
    v_sub_f32 v223, v215, v229
    v_cvt_pk_bf16_f32 v208, v216, v217
    v_cvt_pk_bf16_f32 v209, v218, v219
    v_cvt_pk_bf16_f32 v210, v220, v221
    v_cvt_pk_bf16_f32 v211, v222, v223
    v_lshlrev_b32 v216, 16, v208
    v_and_b32 v217, 0xffff0000, v208
    v_lshlrev_b32 v218, 16, v209
    v_and_b32 v219, 0xffff0000, v209
    v_lshlrev_b32 v220, 16, v210
    v_and_b32 v221, 0xffff0000, v210
    v_lshlrev_b32 v222, 16, v211
    v_and_b32 v223, 0xffff0000, v211
    v_mul_f32 v208, v216, v231
    v_mul_f32 v209, v217, v231
    v_mul_f32 v210, v218, v231
    v_mul_f32 v211, v219, v231
    v_mul_f32 v212, v220, v231
    v_mul_f32 v213, v221, v231
    v_mul_f32 v214, v222, v231
    v_mul_f32 v215, v223, v231
    v_fma_f32 v216, -v208, v230, v216
    v_fma_f32 v217, -v209, v230, v217
    v_fma_f32 v218, -v210, v230, v218
    v_fma_f32 v219, -v211, v230, v219
    v_fma_f32 v220, -v212, v230, v220
    v_fma_f32 v221, -v213, v230, v221
    v_fma_f32 v222, -v214, v230, v222
    v_fma_f32 v223, -v215, v230, v223
    v_fma_f32 v208, v216, v231, v208
    v_fma_f32 v209, v217, v231, v209
    v_fma_f32 v210, v218, v231, v210
    v_fma_f32 v211, v219, v231, v211
    v_fma_f32 v212, v220, v231, v212
    v_fma_f32 v213, v221, v231, v213
    v_fma_f32 v214, v222, v231, v214
    v_fma_f32 v215, v223, v231, v215
    v_cvt_pk_bf16_f32 v216, v208, v209
    v_cvt_pk_bf16_f32 v217, v210, v211
    v_cvt_pk_bf16_f32 v218, v212, v213
    v_cvt_pk_bf16_f32 v219, v214, v215
    ds_write_b128 v6, v[216:219]
    s_waitcnt lgkmcnt(0)
    s_barrier
    v_and_b32 v13, 3, v1
    v_mul_u32_u24 v13, 1088, v13
    v_bfe_u32 v14, v2, 2, 1
    v_lshlrev_b32 v14, 2, v14
    v_add_u32 v14, v14, v3
    v_lshlrev_b32 v14, 4, v14
    s_lshl_b32 s10, s3, 8
    v_add3_u32 v13, v13, v14, s10
    ds_read_b128 v[160:163], v13 offset:0
    ds_read_b128 v[164:167], v13 offset:128
    s_waitcnt lgkmcnt(0)
    s_waitcnt vmcnt(12)
    v_perm_b32 v208, v20, v16, s14
    v_perm_b32 v209, v28, v24, s14
    v_perm_b32 v210, v36, v32, s14
    v_perm_b32 v211, v44, v40, s14
    v_perm_b32 v212, v20, v16, s15
    v_perm_b32 v213, v28, v24, s15
    v_perm_b32 v214, v36, v32, s15
    v_perm_b32 v215, v44, v40, s15
    v_mfma_f32_16x16x32_bf16 v[176:179], v[160:163], v[208:211], 0
    v_perm_b32 v216, v21, v17, s14
    v_perm_b32 v217, v29, v25, s14
    v_perm_b32 v218, v37, v33, s14
    v_perm_b32 v219, v45, v41, s14
    v_mfma_f32_16x16x32_bf16 v[180:183], v[160:163], v[212:215], 0
    v_perm_b32 v220, v21, v17, s15
    v_perm_b32 v221, v29, v25, s15
    v_perm_b32 v222, v37, v33, s15
    v_perm_b32 v223, v45, v41, s15
    v_mfma_f32_16x16x32_bf16 v[184:187], v[160:163], v[216:219], 0
    v_perm_b32 v224, v22, v18, s14
    v_perm_b32 v225, v30, v26, s14
    v_perm_b32 v226, v38, v34, s14
    v_perm_b32 v227, v46, v42, s14
    v_mfma_f32_16x16x32_bf16 v[188:191], v[160:163], v[220:223], 0
    v_perm_b32 v228, v22, v18, s15
    v_perm_b32 v229, v30, v26, s15
    v_perm_b32 v230, v38, v34, s15
    v_perm_b32 v231, v46, v42, s15
    v_mfma_f32_16x16x32_bf16 v[192:195], v[160:163], v[224:227], 0
    v_perm_b32 v232, v23, v19, s14
    v_perm_b32 v233, v31, v27, s14
    v_perm_b32 v234, v39, v35, s14
    v_perm_b32 v235, v47, v43, s14
    v_mfma_f32_16x16x32_bf16 v[196:199], v[160:163], v[228:231], 0
    v_perm_b32 v236, v23, v19, s15
    v_perm_b32 v237, v31, v27, s15
    v_perm_b32 v238, v39, v35, s15
    v_perm_b32 v239, v47, v43, s15
    v_mfma_f32_16x16x32_bf16 v[200:203], v[160:163], v[232:235], 0
    s_nop 1
    v_mfma_f32_16x16x32_bf16 v[204:207], v[160:163], v[236:239], 0
    s_waitcnt vmcnt(4)
    v_perm_b32 v16, v52, v48, s14
    v_perm_b32 v17, v60, v56, s14
    v_perm_b32 v18, v68, v64, s14
    v_perm_b32 v19, v76, v72, s14
    v_perm_b32 v20, v52, v48, s15
    v_perm_b32 v21, v60, v56, s15
    v_perm_b32 v22, v68, v64, s15
    v_perm_b32 v23, v76, v72, s15
    v_mfma_f32_16x16x32_bf16 v[176:179], v[164:167], v[16:19], v[176:179]
    v_perm_b32 v24, v53, v49, s14
    v_perm_b32 v25, v61, v57, s14
    v_perm_b32 v26, v69, v65, s14
    v_perm_b32 v27, v77, v73, s14
    v_mfma_f32_16x16x32_bf16 v[180:183], v[164:167], v[20:23], v[180:183]
    v_perm_b32 v28, v53, v49, s15
    v_perm_b32 v29, v61, v57, s15
    v_perm_b32 v30, v69, v65, s15
    v_perm_b32 v31, v77, v73, s15
    v_mfma_f32_16x16x32_bf16 v[184:187], v[164:167], v[24:27], v[184:187]
    v_perm_b32 v32, v54, v50, s14
    v_perm_b32 v33, v62, v58, s14
    v_perm_b32 v34, v70, v66, s14
    v_perm_b32 v35, v78, v74, s14
    v_mfma_f32_16x16x32_bf16 v[188:191], v[164:167], v[28:31], v[188:191]
    v_perm_b32 v36, v54, v50, s15
    v_perm_b32 v37, v62, v58, s15
    v_perm_b32 v38, v70, v66, s15
    v_perm_b32 v39, v78, v74, s15
    v_mfma_f32_16x16x32_bf16 v[192:195], v[164:167], v[32:35], v[192:195]
    v_perm_b32 v40, v55, v51, s14
    v_perm_b32 v41, v63, v59, s14
    v_perm_b32 v42, v71, v67, s14
    v_perm_b32 v43, v79, v75, s14
    v_mfma_f32_16x16x32_bf16 v[196:199], v[164:167], v[36:39], v[196:199]
    v_perm_b32 v44, v55, v51, s15
    v_perm_b32 v45, v63, v59, s15
    v_perm_b32 v46, v71, v67, s15
    v_perm_b32 v47, v79, v75, s15
    v_mfma_f32_16x16x32_bf16 v[200:203], v[164:167], v[40:43], v[200:203]
    s_nop 1
    v_mfma_f32_16x16x32_bf16 v[204:207], v[164:167], v[44:47], v[204:207]
    s_nop 7
    s_mov_b32 exec_lo, 0xff0000ff
    s_mov_b32 exec_hi, 0
    ds_write_b128 v12, v[176:179] offset:4352
    ds_write_b128 v12, v[180:183] offset:4480
    ds_write_b128 v12, v[184:187] offset:4608
    ds_write_b128 v12, v[188:191] offset:4736
    ds_write_b128 v12, v[192:195] offset:4864
    ds_write_b128 v12, v[196:199] offset:4992
    ds_write_b128 v12, v[200:203] offset:5120
    ds_write_b128 v12, v[204:207] offset:5248
    s_mov_b64 exec, -1
    s_waitcnt lgkmcnt(0)
    s_barrier
    s_cmp_ge_u32 s3, 1
    s_cbranch_scc1 k1_sumdone
    v_lshlrev_b32 v13, 4, v0
    ds_read_b128 v[16:19], v13 offset:4352
    ds_read_b128 v[20:23], v13 offset:5376
    ds_read_b128 v[24:27], v13 offset:6400
    ds_read_b128 v[28:31], v13 offset:7424
    ds_read_b128 v[32:35], v13 offset:8448
    ds_read_b128 v[36:39], v13 offset:9472
    ds_read_b128 v[40:43], v13 offset:10496
    ds_read_b128 v[44:47], v13 offset:11520
    v_lshrrev_b32 v14, 3, v0
    v_lshl_add_u32 v14, v14, 1, v15
    s_waitcnt lgkmcnt(0)
    v_add_f32 v16, v16, v20
    v_add_f32 v24, v24, v28
    v_add_f32 v32, v32, v36
    v_add_f32 v40, v40, v44
    v_add_f32 v17, v17, v21
    v_add_f32 v25, v25, v29
    v_add_f32 v33, v33, v37
    v_add_f32 v41, v41, v45
    v_add_f32 v18, v18, v22
    v_add_f32 v26, v26, v30
    v_add_f32 v34, v34, v38
    v_add_f32 v42, v42, v46
    v_add_f32 v19, v19, v23
    v_add_f32 v27, v27, v31
    v_add_f32 v35, v35, v39
    v_add_f32 v43, v43, v47
    v_add_f32 v16, v16, v24
    v_add_f32 v32, v32, v40
    v_add_f32 v17, v17, v25
    v_add_f32 v33, v33, v41
    v_add_f32 v18, v18, v26
    v_add_f32 v34, v34, v42
    v_add_f32 v19, v19, v27
    v_add_f32 v35, v35, v43
    v_add_f32 v16, v16, v32
    v_add_f32 v17, v17, v33
    v_add_f32 v18, v18, v34
    v_add_f32 v19, v19, v35
    v_cvt_pk_bf16_f32 v20, v16, v17
    v_cvt_pk_bf16_f32 v21, v18, v19
    ds_write_b16 v14, v20 offset:12544
    ds_write_b16_d16_hi v14, v20 offset:12864
    ds_write_b16 v14, v21 offset:13184
    ds_write_b16_d16_hi v14, v21 offset:13504
    s_waitcnt lgkmcnt(0)
k1_sumdone:
    s_barrier
    v_and_b32 v13, 3, v1
    v_mul_u32_u24 v13, 320, v13
    v_lshl_add_u32 v13, v3, 4, v13
    ds_read_b128 v[16:19], v13 offset:12544
    ds_read_b128 v[20:23], v13 offset:12608
    s_waitcnt vmcnt(0) lgkmcnt(0)
    v_mfma_f32_16x16x32_bf16 v[32:35], v[144:147], v[16:19], 0
    v_mfma_f32_16x16x32_bf16 v[36:39], v[152:155], v[16:19], 0
    v_mfma_f32_16x16x32_bf16 v[32:35], v[148:151], v[20:23], v[32:35]
    v_mfma_f32_16x16x32_bf16 v[36:39], v[156:159], v[20:23], v[36:39]
    v_lshlrev_b32 v13, 15, v2
    v_lshlrev_b32 v14, 3, v3
    s_lshl_b32 s10, s6, 10
    s_lshl_b32 s11, s8, 1
    s_add_u32 s10, s10, s11
    s_lshl_b32 s11, s13, 17
    s_add_u32 s10, s10, s11
    v_add3_u32 v13, v13, v14, s10
    v_cmp_gt_u32 vcc, 4, v2
    s_nop 3
    v_mul_f32 v32, 0x3e0293ee, v32
    v_mul_f32 v33, 0x3e0293ee, v33
    v_mul_f32 v34, 0x3e0293ee, v34
    v_mul_f32 v35, 0x3e0293ee, v35
    v_mul_f32 v36, 0x3e0293ee, v36
    v_mul_f32 v37, 0x3e0293ee, v37
    v_mul_f32 v38, 0x3e0293ee, v38
    v_mul_f32 v39, 0x3e0293ee, v39
    v_cvt_pk_bf16_f32 v40, v32, v33
    v_cvt_pk_bf16_f32 v41, v34, v35
    v_cvt_pk_bf16_f32 v42, v36, v37
    v_cvt_pk_bf16_f32 v43, v38, v39
    s_and_saveexec_b64 s[12:13], vcc
    buffer_store_dwordx2 v[40:41], v13, s[56:59], 0 offen offset:0
    buffer_store_dwordx2 v[42:43], v13, s[56:59], 0 offen offset:32
    s_endpgm
k1_ffn:
    s_sub_u32 s4, s2, 256
    s_and_b32 s5, s4, 3
    s_lshr_b32 s6, s4, 2
    s_lshr_b32 s7, s3, 1
    s_and_b32 s8, s3, 1
    s_cmp_eq_u32 s7, 0
    s_cselect_b32 s10, s30, s32
    s_cselect_b32 s11, s31, s33
    s_mov_b32 s48, s10
    s_and_b32 s49, s11, 0xffff
    s_mov_b32 s50, 0x1c0000
    s_mov_b32 s51, 0x20000
    s_lshl_b32 s9, s5, 1
    s_add_u32 s9, s9, s8
    s_mul_i32 s10, s9, 229376
    s_lshl_b32 s11, s6, 7
    s_add_u32 s10, s10, s11
    v_mul_u32_u24 v7, 28672, v3
    v_lshlrev_b32 v12, 3, v2
    v_add3_u32 v7, v7, v12, s10
    s_mov_b32 s10, 0x0
    buffer_load_dwordx2 v[16:17], v7, s[48:51], s10 offen
    s_mov_b32 s10, 0xe00
    buffer_load_dwordx2 v[18:19], v7, s[48:51], s10 offen
    s_mov_b32 s10, 0x1c00
    buffer_load_dwordx2 v[20:21], v7, s[48:51], s10 offen
    s_mov_b32 s10, 0x2a00
    buffer_load_dwordx2 v[22:23], v7, s[48:51], s10 offen
    s_mov_b32 s10, 0x3800
    buffer_load_dwordx2 v[24:25], v7, s[48:51], s10 offen
    s_mov_b32 s10, 0x4600
    buffer_load_dwordx2 v[26:27], v7, s[48:51], s10 offen
    s_mov_b32 s10, 0x5400
    buffer_load_dwordx2 v[28:29], v7, s[48:51], s10 offen
    s_mov_b32 s10, 0x6200
    buffer_load_dwordx2 v[30:31], v7, s[48:51], s10 offen
    s_mov_b32 s10, 0x1c000
    buffer_load_dwordx2 v[32:33], v7, s[48:51], s10 offen
    s_mov_b32 s10, 0x1ce00
    buffer_load_dwordx2 v[34:35], v7, s[48:51], s10 offen
    s_mov_b32 s10, 0x1dc00
    buffer_load_dwordx2 v[36:37], v7, s[48:51], s10 offen
    s_mov_b32 s10, 0x1ea00
    buffer_load_dwordx2 v[38:39], v7, s[48:51], s10 offen
    s_mov_b32 s10, 0x1f800
    buffer_load_dwordx2 v[40:41], v7, s[48:51], s10 offen
    s_mov_b32 s10, 0x20600
    buffer_load_dwordx2 v[42:43], v7, s[48:51], s10 offen
    s_mov_b32 s10, 0x21400
    buffer_load_dwordx2 v[44:45], v7, s[48:51], s10 offen
    s_mov_b32 s10, 0x22200
    buffer_load_dwordx2 v[46:47], v7, s[48:51], s10 offen
    s_waitcnt vmcnt(16)
    v_lshlrev_b32 v208, 16, v8
    v_and_b32 v209, 0xffff0000, v8
    v_lshlrev_b32 v210, 16, v9
    v_and_b32 v211, 0xffff0000, v9
    v_lshlrev_b32 v212, 16, v10
    v_and_b32 v213, 0xffff0000, v10
    v_lshlrev_b32 v214, 16, v11
    v_and_b32 v215, 0xffff0000, v11
    v_add_f32 v224, v208, v209
    v_add_f32 v224, v224, v210
    v_add_f32 v224, v224, v211
    v_add_f32 v224, v224, v212
    v_add_f32 v224, v224, v213
    v_add_f32 v224, v224, v214
    v_add_f32 v224, v224, v215
    s_nop 1
    v_add_f32_dpp v225, v224, v224 quad_perm:[1,0,3,2] row_mask:0xf bank_mask:0xf
    s_nop 1
    v_add_f32_dpp v224, v225, v225 quad_perm:[2,3,0,1] row_mask:0xf bank_mask:0xf
    s_nop 1
    v_add_f32_dpp v225, v224, v224 row_half_mirror row_mask:0xf bank_mask:0xf
    s_nop 1
    v_add_f32_dpp v224, v225, v225 row_mirror row_mask:0xf bank_mask:0xf
    v_mov_b32 v225, v224
    s_nop 1
    v_permlane16_swap_b32 v224, v225
    s_nop 0
    v_add_f32 v224, v224, v225
    v_mov_b32 v225, v224
    s_nop 1
    v_permlane32_swap_b32 v224, v225
    s_nop 0
    v_add_f32 v224, v224, v225
    v_mul_f32 v226, 0x3b000000, v224
    v_sub_f32 v216, v208, v226
    v_sub_f32 v217, v209, v226
    v_sub_f32 v218, v210, v226
    v_sub_f32 v219, v211, v226
    v_sub_f32 v220, v212, v226
    v_sub_f32 v221, v213, v226
    v_sub_f32 v222, v214, v226
    v_sub_f32 v223, v215, v226
    v_mul_f32 v224, v216, v216
    v_fma_f32 v224, v217, v217, v224
    v_fma_f32 v224, v218, v218, v224
    v_fma_f32 v224, v219, v219, v224
    v_fma_f32 v224, v220, v220, v224
    v_fma_f32 v224, v221, v221, v224
    v_fma_f32 v224, v222, v222, v224
    v_fma_f32 v224, v223, v223, v224
    s_nop 1
    v_add_f32_dpp v225, v224, v224 quad_perm:[1,0,3,2] row_mask:0xf bank_mask:0xf
    s_nop 1
    v_add_f32_dpp v224, v225, v225 quad_perm:[2,3,0,1] row_mask:0xf bank_mask:0xf
    s_nop 1
    v_add_f32_dpp v225, v224, v224 row_half_mirror row_mask:0xf bank_mask:0xf
    s_nop 1
    v_add_f32_dpp v224, v225, v225 row_mirror row_mask:0xf bank_mask:0xf
    v_mov_b32 v225, v224
    s_nop 1
    v_permlane16_swap_b32 v224, v225
    s_nop 0
    v_add_f32 v224, v224, v225
    v_mov_b32 v225, v224
    s_nop 1
    v_permlane32_swap_b32 v224, v225
    s_nop 0
    v_add_f32 v224, v224, v225
    v_mul_f32 v224, 0x3b000000, v224
    v_cvt_pk_bf16_f32 v227, v224, v226
    v_lshlrev_b32 v228, 16, v227
    v_and_b32 v229, 0xffff0000, v227
    v_add_f32 v228, 0x3727c5ac, v228
    v_cvt_pk_bf16_f32 v227, v228, v228
    v_lshlrev_b32 v228, 16, v227
    v_sqrt_f32 v230, v228
    s_nop 0
    v_cvt_pk_bf16_f32 v227, v230, v230
    v_lshlrev_b32 v230, 16, v227
    v_rcp_f32 v231, v230
    v_sub_f32 v216, v208, v229
    v_sub_f32 v217, v209, v229
    v_sub_f32 v218, v210, v229
    v_sub_f32 v219, v211, v229
    v_sub_f32 v220, v212, v229
    v_sub_f32 v221, v213, v229
    v_sub_f32 v222, v214, v229
    v_sub_f32 v223, v215, v229
    v_cvt_pk_bf16_f32 v208, v216, v217
    v_cvt_pk_bf16_f32 v209, v218, v219
    v_cvt_pk_bf16_f32 v210, v220, v221
    v_cvt_pk_bf16_f32 v211, v222, v223
    v_lshlrev_b32 v216, 16, v208
    v_and_b32 v217, 0xffff0000, v208
    v_lshlrev_b32 v218, 16, v209
    v_and_b32 v219, 0xffff0000, v209
    v_lshlrev_b32 v220, 16, v210
    v_and_b32 v221, 0xffff0000, v210
    v_lshlrev_b32 v222, 16, v211
    v_and_b32 v223, 0xffff0000, v211
    v_mul_f32 v208, v216, v231
    v_mul_f32 v209, v217, v231
    v_mul_f32 v210, v218, v231
    v_mul_f32 v211, v219, v231
    v_mul_f32 v212, v220, v231
    v_mul_f32 v213, v221, v231
    v_mul_f32 v214, v222, v231
    v_mul_f32 v215, v223, v231
    v_fma_f32 v216, -v208, v230, v216
    v_fma_f32 v217, -v209, v230, v217
    v_fma_f32 v218, -v210, v230, v218
    v_fma_f32 v219, -v211, v230, v219
    v_fma_f32 v220, -v212, v230, v220
    v_fma_f32 v221, -v213, v230, v221
    v_fma_f32 v222, -v214, v230, v222
    v_fma_f32 v223, -v215, v230, v223
    v_fma_f32 v208, v216, v231, v208
    v_fma_f32 v209, v217, v231, v209
    v_fma_f32 v210, v218, v231, v210
    v_fma_f32 v211, v219, v231, v211
    v_fma_f32 v212, v220, v231, v212
    v_fma_f32 v213, v221, v231, v213
    v_fma_f32 v214, v222, v231, v214
    v_fma_f32 v215, v223, v231, v215
    v_cvt_pk_bf16_f32 v216, v208, v209
    v_cvt_pk_bf16_f32 v217, v210, v211
    v_cvt_pk_bf16_f32 v218, v212, v213
    v_cvt_pk_bf16_f32 v219, v214, v215
    ds_write_b128 v6, v[216:219]
    s_waitcnt lgkmcnt(0)
    s_barrier
    v_and_b32 v13, 3, v1
    v_mul_u32_u24 v13, 1088, v13
    v_lshlrev_b32 v14, 4, v3
    s_lshl_b32 s10, s9, 7
    v_add3_u32 v13, v13, v14, s10
    ds_read_b128 v[160:163], v13 offset:0
    ds_read_b128 v[164:167], v13 offset:64
    s_waitcnt lgkmcnt(0)
    s_waitcnt vmcnt(8)
    v_perm_b32 v208, v18, v16, s14
    v_perm_b32 v209, v22, v20, s14
    v_perm_b32 v210, v26, v24, s14
    v_perm_b32 v211, v30, v28, s14
    v_perm_b32 v212, v18, v16, s15
    v_perm_b32 v213, v22, v20, s15
    v_perm_b32 v214, v26, v24, s15
    v_perm_b32 v215, v30, v28, s15
    v_mfma_f32_16x16x32_bf16 v[176:179], v[160:163], v[208:211], 0
    v_perm_b32 v216, v19, v17, s14
    v_perm_b32 v217, v23, v21, s14
    v_perm_b32 v218, v27, v25, s14
    v_perm_b32 v219, v31, v29, s14
    v_mfma_f32_16x16x32_bf16 v[180:183], v[160:163], v[212:215], 0
    v_perm_b32 v220, v19, v17, s15
    v_perm_b32 v221, v23, v21, s15
    v_perm_b32 v222, v27, v25, s15
    v_perm_b32 v223, v31, v29, s15
    v_mfma_f32_16x16x32_bf16 v[184:187], v[160:163], v[216:219], 0
    s_nop 1
    v_mfma_f32_16x16x32_bf16 v[188:191], v[160:163], v[220:223], 0
    s_waitcnt vmcnt(0)
    v_perm_b32 v224, v34, v32, s14
    v_perm_b32 v225, v38, v36, s14
    v_perm_b32 v226, v42, v40, s14
    v_perm_b32 v227, v46, v44, s14
    v_perm_b32 v228, v34, v32, s15
    v_perm_b32 v229, v38, v36, s15
    v_perm_b32 v230, v42, v40, s15
    v_perm_b32 v231, v46, v44, s15
    v_mfma_f32_16x16x32_bf16 v[176:179], v[164:167], v[224:227], v[176:179]
    v_perm_b32 v232, v35, v33, s14
    v_perm_b32 v233, v39, v37, s14
    v_perm_b32 v234, v43, v41, s14
    v_perm_b32 v235, v47, v45, s14
    v_mfma_f32_16x16x32_bf16 v[180:183], v[164:167], v[228:231], v[180:183]
    v_perm_b32 v236, v35, v33, s15
    v_perm_b32 v237, v39, v37, s15
    v_perm_b32 v238, v43, v41, s15
    v_perm_b32 v239, v47, v45, s15
    v_mfma_f32_16x16x32_bf16 v[184:187], v[164:167], v[232:235], v[184:187]
    s_nop 1
    v_mfma_f32_16x16x32_bf16 v[188:191], v[164:167], v[236:239], v[188:191]
    s_lshl_b32 s10, s9, 1
    s_add_u32 s10, s10, s7
    s_mul_i32 s10, s10, 28672
    s_lshl_b32 s11, s6, 10
    s_add_u32 s10, s10, s11
    s_add_u32 s10, s10, 0x40000
    v_lshlrev_b32 v13, 6, v2
    v_add_u32 v13, s10, v13
    s_nop 7
    s_mov_b64 exec, 0xffff
    buffer_store_dwordx4 v[176:179], v13, s[56:59], 0 offen offset:0
    buffer_store_dwordx4 v[180:183], v13, s[56:59], 0 offen offset:16
    buffer_store_dwordx4 v[184:187], v13, s[56:59], 0 offen offset:32
    buffer_store_dwordx4 v[188:191], v13, s[56:59], 0 offen offset:48
k1_end:
    s_endpgm
.globl k2_kernel
.p2align 8
.type k2_kernel,@function
k2_kernel:
    s_cmp_ge_u32 s2, 256
    s_cbranch_scc1 k2_end
    s_load_dwordx16 s[16:31], s[0:1], 0
    s_load_dwordx8 s[32:39], s[0:1], 64
    s_load_dwordx2 s[40:41], s[0:1], 96
    v_lshrrev_b32 v3, 6, v0
    v_and_b32 v1, 63, v0
    v_readfirstlane_b32 s3, v3
    v_and_b32 v2, 15, v1
    v_lshrrev_b32 v3, 4, v1
    s_mov_b32 s14, 0x05040100
    s_mov_b32 s15, 0x07060302
    s_waitcnt lgkmcnt(0)
    s_and_b32 s4, s2, 7
    s_lshr_b32 s5, s2, 3
    s_and_b32 s6, s5, 1
    s_lshr_b32 s5, s5, 1
    s_lshl_b32 s5, s5, 3
    s_add_u32 s5, s5, s4
    s_lshr_b32 s7, s5, 5
    s_and_b32 s8, s5, 31
    s_lshl_b32 s9, s5, 17
    s_add_u32 s44, s18, s9
    s_addc_u32 s45, s19, 0
    s_and_b32 s45, s45, 0xffff
    s_mov_b32 s46, 0x20000
    s_mov_b32 s47, 0x20000
    s_mov_b32 s48, s40
    s_and_b32 s49, s41, 0xffff
    s_mov_b32 s50, 0x800000
    s_mov_b32 s51, 0x20000
    s_cmp_lt_u32 s3, 4
    s_cbranch_scc1 k2_comp
    s_and_b32 s3, s3, 3
    v_lshlrev_b32 v5, 4, v1
    s_mul_i32 s10, s3, 33792
    s_lshl_b32 s11, s3, 15
    s_mul_i32 s64, s3, 4224
    s_lshl_b32 s65, s3, 12
    s_add_u32 m0, s10, 4608
    s_add_u32 s12, s11, 0
    buffer_load_dwordx4 v5, s[44:47], s12 offen lds
    s_add_u32 m0, s10, 5664
    s_add_u32 s12, s11, 1024
    buffer_load_dwordx4 v5, s[44:47], s12 offen lds
    s_add_u32 m0, s10, 6720
    s_add_u32 s12, s11, 2048
    buffer_load_dwordx4 v5, s[44:47], s12 offen lds
    s_add_u32 m0, s10, 7776
    s_add_u32 s12, s11, 3072
    buffer_load_dwordx4 v5, s[44:47], s12 offen lds
    s_add_u32 m0, s10, 8832
    s_add_u32 s12, s11, 4096
    buffer_load_dwordx4 v5, s[44:47], s12 offen lds
    s_add_u32 m0, s10, 9888
    s_add_u32 s12, s11, 5120
    buffer_load_dwordx4 v5, s[44:47], s12 offen lds
    s_add_u32 m0, s10, 10944
    s_add_u32 s12, s11, 6144
    buffer_load_dwordx4 v5, s[44:47], s12 offen lds
    s_add_u32 m0, s10, 12000
    s_add_u32 s12, s11, 7168
    buffer_load_dwordx4 v5, s[44:47], s12 offen lds
    s_add_u32 m0, s10, 13056
    s_add_u32 s12, s11, 8192
    buffer_load_dwordx4 v5, s[44:47], s12 offen lds
    s_add_u32 m0, s10, 14112
    s_add_u32 s12, s11, 9216
    buffer_load_dwordx4 v5, s[44:47], s12 offen lds
    s_add_u32 m0, s10, 15168
    s_add_u32 s12, s11, 10240
    buffer_load_dwordx4 v5, s[44:47], s12 offen lds
    s_add_u32 m0, s10, 16224
    s_add_u32 s12, s11, 11264
    buffer_load_dwordx4 v5, s[44:47], s12 offen lds
    s_barrier
    s_add_u32 m0, s10, 17280
    s_add_u32 s12, s11, 12288
    buffer_load_dwordx4 v5, s[44:47], s12 offen lds
    s_add_u32 m0, s10, 18336
    s_add_u32 s12, s11, 13312
    buffer_load_dwordx4 v5, s[44:47], s12 offen lds
    s_add_u32 m0, s10, 19392
    s_add_u32 s12, s11, 14336
    buffer_load_dwordx4 v5, s[44:47], s12 offen lds
    s_add_u32 m0, s10, 20448
    s_add_u32 s12, s11, 15360
    buffer_load_dwordx4 v5, s[44:47], s12 offen lds
    s_add_u32 m0, s10, 21504
    s_add_u32 s12, s11, 16384
    buffer_load_dwordx4 v5, s[44:47], s12 offen lds
    s_add_u32 m0, s10, 22560
    s_add_u32 s12, s11, 17408
    buffer_load_dwordx4 v5, s[44:47], s12 offen lds
    s_add_u32 m0, s10, 23616
    s_add_u32 s12, s11, 18432
    buffer_load_dwordx4 v5, s[44:47], s12 offen lds
    s_add_u32 m0, s10, 24672
    s_add_u32 s12, s11, 19456
    buffer_load_dwordx4 v5, s[44:47], s12 offen lds
    s_add_u32 m0, s10, 25728
    s_add_u32 s12, s11, 20480
    buffer_load_dwordx4 v5, s[44:47], s12 offen lds
    s_add_u32 m0, s10, 26784
    s_add_u32 s12, s11, 21504
    buffer_load_dwordx4 v5, s[44:47], s12 offen lds
    s_add_u32 m0, s10, 27840
    s_add_u32 s12, s11, 22528
    buffer_load_dwordx4 v5, s[44:47], s12 offen lds
    s_add_u32 m0, s10, 28896
    s_add_u32 s12, s11, 23552
    buffer_load_dwordx4 v5, s[44:47], s12 offen lds
    s_waitcnt vmcnt(8)
    s_barrier
    s_add_u32 m0, s10, 29952
    s_add_u32 s12, s11, 24576
    buffer_load_dwordx4 v5, s[44:47], s12 offen lds
    s_add_u32 m0, s10, 31008
    s_add_u32 s12, s11, 25600
    buffer_load_dwordx4 v5, s[44:47], s12 offen lds
    s_add_u32 m0, s10, 32064
    s_add_u32 s12, s11, 26624
    buffer_load_dwordx4 v5, s[44:47], s12 offen lds
    s_add_u32 m0, s10, 33120
    s_add_u32 s12, s11, 27648
    buffer_load_dwordx4 v5, s[44:47], s12 offen lds
    s_add_u32 m0, s10, 34176
    s_add_u32 s12, s11, 28672
    buffer_load_dwordx4 v5, s[44:47], s12 offen lds
    s_add_u32 m0, s10, 35232
    s_add_u32 s12, s11, 29696
    buffer_load_dwordx4 v5, s[44:47], s12 offen lds
    s_add_u32 m0, s10, 36288
    s_add_u32 s12, s11, 30720
    buffer_load_dwordx4 v5, s[44:47], s12 offen lds
    s_add_u32 m0, s10, 37344
    s_add_u32 s12, s11, 31744
    buffer_load_dwordx4 v5, s[44:47], s12 offen lds
    s_barrier
    s_barrier
    s_waitcnt vmcnt(0)
    s_barrier
    s_endpgm
k2_comp:
    s_lshl_b32 s9, s7, 5
    s_lshl_b32 s10, s6, 4
    s_add_u32 s9, s9, s10
    s_lshl_b32 s10, s3, 2
    s_add_u32 s10, s10, s9
    s_lshl_b32 s10, s10, 10
    v_lshlrev_b32 v4, 4, v1
    v_add_u32 v4, s10, v4
    s_mov_b32 s10, 0x20000
    buffer_load_dwordx4 v[144:147], v4, s[48:51], 0 offen offset:0
    buffer_load_dwordx4 v[160:163], v4, s[48:51], s10 offen offset:0
    buffer_load_dwordx4 v[148:151], v4, s[48:51], 0 offen offset:1024
    buffer_load_dwordx4 v[164:167], v4, s[48:51], s10 offen offset:1024
    buffer_load_dwordx4 v[152:155], v4, s[48:51], 0 offen offset:2048
    buffer_load_dwordx4 v[168:171], v4, s[48:51], s10 offen offset:2048
    buffer_load_dwordx4 v[156:159], v4, s[48:51], 0 offen offset:3072
    buffer_load_dwordx4 v[172:175], v4, s[48:51], s10 offen offset:3072
    v_lshlrev_b32 v5, 4, v1
    s_mul_i32 s10, s3, 33792
    s_lshl_b32 s11, s3, 15
    v_mul_u32_u24 v6, 1056, v2
    v_lshlrev_b32 v7, 4, v3
    v_add3_u32 v6, v6, v7, s10
    s_mul_i32 s12, s3, 4224
    s_add_u32 s12, s12, 139776
    v_add_u32 v4, s12, v5
    v_mul_u32_u24 v12, 1056, v2
    s_mov_b32 s13, 139776
    v_add3_u32 v12, v12, v7, s13
    s_waitcnt vmcnt(6)
    v_lshlrev_b32 v8, 16, v144
    v_lshlrev_b32 v9, 16, v160
    v_and_b32 v10, 0xffff0000, v144
    v_and_b32 v11, 0xffff0000, v160
    v_add_f32 v8, v8, v9
    v_add_f32 v10, v10, v11
    v_cvt_pk_bf16_f32 v144, v8, v10
    v_lshlrev_b32 v8, 16, v145
    v_lshlrev_b32 v9, 16, v161
    v_and_b32 v10, 0xffff0000, v145
    v_and_b32 v11, 0xffff0000, v161
    v_add_f32 v8, v8, v9
    v_add_f32 v10, v10, v11
    v_cvt_pk_bf16_f32 v145, v8, v10
    v_lshlrev_b32 v8, 16, v146
    v_lshlrev_b32 v9, 16, v162
    v_and_b32 v10, 0xffff0000, v146
    v_and_b32 v11, 0xffff0000, v162
    v_add_f32 v8, v8, v9
    v_add_f32 v10, v10, v11
    v_cvt_pk_bf16_f32 v146, v8, v10
    v_lshlrev_b32 v8, 16, v147
    v_lshlrev_b32 v9, 16, v163
    v_and_b32 v10, 0xffff0000, v147
    v_and_b32 v11, 0xffff0000, v163
    v_add_f32 v8, v8, v9
    v_add_f32 v10, v10, v11
    v_cvt_pk_bf16_f32 v147, v8, v10
    ds_write_b128 v4, v[144:147] offset:0
    s_waitcnt vmcnt(4)
    v_lshlrev_b32 v8, 16, v148
    v_lshlrev_b32 v9, 16, v164
    v_and_b32 v10, 0xffff0000, v148
    v_and_b32 v11, 0xffff0000, v164
    v_add_f32 v8, v8, v9
    v_add_f32 v10, v10, v11
    v_cvt_pk_bf16_f32 v148, v8, v10
    v_lshlrev_b32 v8, 16, v149
    v_lshlrev_b32 v9, 16, v165
    v_and_b32 v10, 0xffff0000, v149
    v_and_b32 v11, 0xffff0000, v165
    v_add_f32 v8, v8, v9
    v_add_f32 v10, v10, v11
    v_cvt_pk_bf16_f32 v149, v8, v10
    v_lshlrev_b32 v8, 16, v150
    v_lshlrev_b32 v9, 16, v166
    v_and_b32 v10, 0xffff0000, v150
    v_and_b32 v11, 0xffff0000, v166
    v_add_f32 v8, v8, v9
    v_add_f32 v10, v10, v11
    v_cvt_pk_bf16_f32 v150, v8, v10
    v_lshlrev_b32 v8, 16, v151
    v_lshlrev_b32 v9, 16, v167
    v_and_b32 v10, 0xffff0000, v151
    v_and_b32 v11, 0xffff0000, v167
    v_add_f32 v8, v8, v9
    v_add_f32 v10, v10, v11
    v_cvt_pk_bf16_f32 v151, v8, v10
    ds_write_b128 v4, v[148:151] offset:1056
    s_waitcnt vmcnt(2)
    v_lshlrev_b32 v8, 16, v152
    v_lshlrev_b32 v9, 16, v168
    v_and_b32 v10, 0xffff0000, v152
    v_and_b32 v11, 0xffff0000, v168
    v_add_f32 v8, v8, v9
    v_add_f32 v10, v10, v11
    v_cvt_pk_bf16_f32 v152, v8, v10
    v_lshlrev_b32 v8, 16, v153
    v_lshlrev_b32 v9, 16, v169
    v_and_b32 v10, 0xffff0000, v153
    v_and_b32 v11, 0xffff0000, v169
    v_add_f32 v8, v8, v9
    v_add_f32 v10, v10, v11
    v_cvt_pk_bf16_f32 v153, v8, v10
    v_lshlrev_b32 v8, 16, v154
    v_lshlrev_b32 v9, 16, v170
    v_and_b32 v10, 0xffff0000, v154
    v_and_b32 v11, 0xffff0000, v170
    v_add_f32 v8, v8, v9
    v_add_f32 v10, v10, v11
    v_cvt_pk_bf16_f32 v154, v8, v10
    v_lshlrev_b32 v8, 16, v155
    v_lshlrev_b32 v9, 16, v171
    v_and_b32 v10, 0xffff0000, v155
    v_and_b32 v11, 0xffff0000, v171
    v_add_f32 v8, v8, v9
    v_add_f32 v10, v10, v11
    v_cvt_pk_bf16_f32 v155, v8, v10
    ds_write_b128 v4, v[152:155] offset:2112
    s_waitcnt vmcnt(0)
    v_lshlrev_b32 v8, 16, v156
    v_lshlrev_b32 v9, 16, v172
    v_and_b32 v10, 0xffff0000, v156
    v_and_b32 v11, 0xffff0000, v172
    v_add_f32 v8, v8, v9
    v_add_f32 v10, v10, v11
    v_cvt_pk_bf16_f32 v156, v8, v10
    v_lshlrev_b32 v8, 16, v157
    v_lshlrev_b32 v9, 16, v173
    v_and_b32 v10, 0xffff0000, v157
    v_and_b32 v11, 0xffff0000, v173
    v_add_f32 v8, v8, v9
    v_add_f32 v10, v10, v11
    v_cvt_pk_bf16_f32 v157, v8, v10
    v_lshlrev_b32 v8, 16, v158
    v_lshlrev_b32 v9, 16, v174
    v_and_b32 v10, 0xffff0000, v158
    v_and_b32 v11, 0xffff0000, v174
    v_add_f32 v8, v8, v9
    v_add_f32 v10, v10, v11
    v_cvt_pk_bf16_f32 v158, v8, v10
    v_lshlrev_b32 v8, 16, v159
    v_lshlrev_b32 v9, 16, v175
    v_and_b32 v10, 0xffff0000, v159
    v_and_b32 v11, 0xffff0000, v175
    v_add_f32 v8, v8, v9
    v_add_f32 v10, v10, v11
    v_cvt_pk_bf16_f32 v159, v8, v10
    ds_write_b128 v4, v[156:159] offset:3168
    s_waitcnt lgkmcnt(0)
    s_barrier
    ds_read_b128 v[16:19], v12 offset:0
    ds_read_b128 v[20:23], v12 offset:64
    ds_read_b128 v[24:27], v12 offset:128
    ds_read_b128 v[28:31], v12 offset:192
    ds_read_b128 v[32:35], v12 offset:256
    ds_read_b128 v[36:39], v12 offset:320
    ds_read_b128 v[40:43], v12 offset:384
    ds_read_b128 v[44:47], v12 offset:448
    ds_read_b128 v[48:51], v12 offset:512
    ds_read_b128 v[52:55], v12 offset:576
    ds_read_b128 v[56:59], v12 offset:640
    ds_read_b128 v[60:63], v12 offset:704
    ds_read_b128 v[64:67], v12 offset:768
    ds_read_b128 v[68:71], v12 offset:832
    ds_read_b128 v[72:75], v12 offset:896
    ds_read_b128 v[76:79], v12 offset:960
    v_lshrrev_b32 v13, 2, v2
    v_lshl_add_u32 v13, v3, 2, v13
    v_mul_u32_u24 v13, 1056, v13
    v_and_b32 v14, 3, v2
    v_lshlrev_b32 v14, 3, v14
    s_lshl_b32 s12, s3, 8
    v_add3_u32 v211, v13, v14, s12
    v_add_u32 v212, 67584, v211
    s_lshl_b32 s12, s3, 6
    v_lshlrev_b32 v10, 2, v2
    v_add_u32 v11, s12, v10
    s_lshr_b32 s12, s3, 1
    s_lshl_b32 s12, s12, 10
    s_and_b32 s13, s3, 1
    s_lshl_b32 s13, s13, 3
    s_add_u32 s12, s12, s13
    v_add_u32 v213, s12, v5
    s_barrier
    ds_read_b128 v[80:83], v6 offset:4608
    ds_read_b128 v[84:87], v6 offset:4672
    ds_read_b128 v[88:91], v6 offset:4736
    ds_read_b128 v[92:95], v6 offset:4800
    ds_read_b128 v[96:99], v6 offset:4864
    ds_read_b128 v[100:103], v6 offset:4928
    ds_read_b128 v[104:107], v6 offset:4992
    ds_read_b128 v[108:111], v6 offset:5056
    ds_read_b128 v[112:115], v6 offset:5120
    ds_read_b128 v[116:119], v6 offset:5184
    ds_read_b128 v[120:123], v6 offset:5248
    ds_read_b128 v[124:127], v6 offset:5312
    ds_read_b128 v[128:131], v6 offset:5376
    ds_read_b128 v[132:135], v6 offset:5440
    ds_read_b128 v[136:139], v6 offset:5504
    ds_read_b128 v[140:143], v6 offset:5568
    s_waitcnt lgkmcnt(15)
    v_mfma_f32_16x16x32_bf16 v[144:147], v[80:83], v[16:19], 0
    s_waitcnt lgkmcnt(14)
    v_mfma_f32_16x16x32_bf16 v[144:147], v[84:87], v[20:23], v[144:147]
    s_waitcnt lgkmcnt(13)
    v_mfma_f32_16x16x32_bf16 v[144:147], v[88:91], v[24:27], v[144:147]
    s_waitcnt lgkmcnt(12)
    v_mfma_f32_16x16x32_bf16 v[144:147], v[92:95], v[28:31], v[144:147]
    s_waitcnt lgkmcnt(11)
    v_mfma_f32_16x16x32_bf16 v[144:147], v[96:99], v[32:35], v[144:147]
    s_waitcnt lgkmcnt(10)
    v_mfma_f32_16x16x32_bf16 v[144:147], v[100:103], v[36:39], v[144:147]
    s_waitcnt lgkmcnt(9)
    v_mfma_f32_16x16x32_bf16 v[144:147], v[104:107], v[40:43], v[144:147]
    s_waitcnt lgkmcnt(8)
    v_mfma_f32_16x16x32_bf16 v[144:147], v[108:111], v[44:47], v[144:147]
    s_waitcnt lgkmcnt(7)
    v_mfma_f32_16x16x32_bf16 v[144:147], v[112:115], v[48:51], v[144:147]
    s_waitcnt lgkmcnt(6)
    v_mfma_f32_16x16x32_bf16 v[144:147], v[116:119], v[52:55], v[144:147]
    s_waitcnt lgkmcnt(5)
    v_mfma_f32_16x16x32_bf16 v[144:147], v[120:123], v[56:59], v[144:147]
    s_waitcnt lgkmcnt(4)
    v_mfma_f32_16x16x32_bf16 v[144:147], v[124:127], v[60:63], v[144:147]
    s_waitcnt lgkmcnt(3)
    v_mfma_f32_16x16x32_bf16 v[144:147], v[128:131], v[64:67], v[144:147]
    s_waitcnt lgkmcnt(2)
    v_mfma_f32_16x16x32_bf16 v[144:147], v[132:135], v[68:71], v[144:147]
    s_waitcnt lgkmcnt(1)
    v_mfma_f32_16x16x32_bf16 v[144:147], v[136:139], v[72:75], v[144:147]
    s_waitcnt lgkmcnt(0)
    v_mfma_f32_16x16x32_bf16 v[144:147], v[140:143], v[76:79], v[144:147]
    s_nop 7
    v_max3_f32 v8, v144, v145, v146
    v_max_f32 v8, v8, v147
    v_mov_b32 v9, v8
    s_nop 1
    v_permlane16_swap_b32 v8, v9
    s_nop 0
    v_max_f32 v8, v8, v9
    v_mov_b32 v9, v8
    s_nop 1
    v_permlane32_swap_b32 v8, v9
    s_nop 0
    v_max_f32 v8, v8, v9
    s_mov_b64 exec, 0xffff
    ds_write_b32 v11, v8 offset:4096
    s_mov_b64 exec, -1
    s_waitcnt lgkmcnt(0)
    s_barrier
    ds_read_b32 v12, v10 offset:4096
    ds_read_b32 v13, v10 offset:4160
    ds_read_b32 v14, v10 offset:4224
    ds_read_b32 v15, v10 offset:4288
    s_waitcnt lgkmcnt(0)
    v_max3_f32 v8, v12, v13, v14
    v_max_f32 v208, v8, v15
    v_mov_b32 v8, v208
    v_sub_f32 v144, v144, v8
    v_sub_f32 v145, v145, v8
    v_sub_f32 v146, v146, v8
    v_sub_f32 v147, v147, v8
    v_exp_f32 v144, v144
    v_exp_f32 v145, v145
    v_exp_f32 v146, v146
    v_exp_f32 v147, v147
    s_nop 0
    v_cvt_pk_bf16_f32 v152, v144, v145
    v_cvt_pk_bf16_f32 v153, v146, v147
    ds_write_b64 v213, v[152:153] offset:0
    v_add_f32 v9, v144, v145
    v_add_f32 v9, v9, v146
    v_add_f32 v209, v9, v147
    s_waitcnt lgkmcnt(0)
    s_barrier
    ds_read_b128 v[156:159], v5 offset:0
    ds_read_b128 v[160:163], v5 offset:1024
    ds_read_b64_tr_b16 v[80:81], v211 offset:4608
    ds_read_b64_tr_b16 v[82:83], v211 offset:38400
    ds_read_b64_tr_b16 v[84:85], v211 offset:4640
    ds_read_b64_tr_b16 v[86:87], v211 offset:38432
    ds_read_b64_tr_b16 v[88:89], v211 offset:4672
    ds_read_b64_tr_b16 v[90:91], v211 offset:38464
    ds_read_b64_tr_b16 v[92:93], v211 offset:4704
    ds_read_b64_tr_b16 v[94:95], v211 offset:38496
    ds_read_b64_tr_b16 v[96:97], v211 offset:4736
    ds_read_b64_tr_b16 v[98:99], v211 offset:38528
    ds_read_b64_tr_b16 v[100:101], v211 offset:4768
    ds_read_b64_tr_b16 v[102:103], v211 offset:38560
    ds_read_b64_tr_b16 v[104:105], v211 offset:4800
    ds_read_b64_tr_b16 v[106:107], v211 offset:38592
    ds_read_b64_tr_b16 v[108:109], v211 offset:4832
    ds_read_b64_tr_b16 v[110:111], v211 offset:38624
    s_waitcnt lgkmcnt(8)
    v_mfma_f32_16x16x32_bf16 v[176:179], v[80:83], v[156:159], 0
    v_mfma_f32_16x16x32_bf16 v[180:183], v[84:87], v[156:159], 0
    v_mfma_f32_16x16x32_bf16 v[184:187], v[88:91], v[156:159], 0
    v_mfma_f32_16x16x32_bf16 v[188:191], v[92:95], v[156:159], 0
    ds_read_b64_tr_b16 v[112:113], v212 offset:4608
    ds_read_b64_tr_b16 v[114:115], v212 offset:38400
    ds_read_b64_tr_b16 v[116:117], v212 offset:4640
    ds_read_b64_tr_b16 v[118:119], v212 offset:38432
    ds_read_b64_tr_b16 v[120:121], v212 offset:4672
    ds_read_b64_tr_b16 v[122:123], v212 offset:38464
    ds_read_b64_tr_b16 v[124:125], v212 offset:4704
    ds_read_b64_tr_b16 v[126:127], v212 offset:38496
    s_waitcnt lgkmcnt(8)
    v_mfma_f32_16x16x32_bf16 v[192:195], v[96:99], v[156:159], 0
    v_mfma_f32_16x16x32_bf16 v[196:199], v[100:103], v[156:159], 0
    v_mfma_f32_16x16x32_bf16 v[200:203], v[104:107], v[156:159], 0
    v_mfma_f32_16x16x32_bf16 v[204:207], v[108:111], v[156:159], 0
    ds_read_b64_tr_b16 v[128:129], v212 offset:4736
    ds_read_b64_tr_b16 v[130:131], v212 offset:38528
    ds_read_b64_tr_b16 v[132:133], v212 offset:4768
    ds_read_b64_tr_b16 v[134:135], v212 offset:38560
    ds_read_b64_tr_b16 v[136:137], v212 offset:4800
    ds_read_b64_tr_b16 v[138:139], v212 offset:38592
    ds_read_b64_tr_b16 v[140:141], v212 offset:4832
    ds_read_b64_tr_b16 v[142:143], v212 offset:38624
    s_waitcnt lgkmcnt(8)
    v_mfma_f32_16x16x32_bf16 v[176:179], v[112:115], v[160:163], v[176:179]
    v_mfma_f32_16x16x32_bf16 v[180:183], v[116:119], v[160:163], v[180:183]
    v_mfma_f32_16x16x32_bf16 v[184:187], v[120:123], v[160:163], v[184:187]
    v_mfma_f32_16x16x32_bf16 v[188:191], v[124:127], v[160:163], v[188:191]
    s_waitcnt lgkmcnt(0)
    v_mfma_f32_16x16x32_bf16 v[192:195], v[128:131], v[160:163], v[192:195]
    v_mfma_f32_16x16x32_bf16 v[196:199], v[132:135], v[160:163], v[196:199]
    v_mfma_f32_16x16x32_bf16 v[200:203], v[136:139], v[160:163], v[200:203]
    v_mfma_f32_16x16x32_bf16 v[204:207], v[140:143], v[160:163], v[204:207]
    s_barrier
    ds_read_b128 v[80:83], v6 offset:21504
    ds_read_b128 v[84:87], v6 offset:21568
    ds_read_b128 v[88:91], v6 offset:21632
    ds_read_b128 v[92:95], v6 offset:21696
    ds_read_b128 v[96:99], v6 offset:21760
    ds_read_b128 v[100:103], v6 offset:21824
    ds_read_b128 v[104:107], v6 offset:21888
    ds_read_b128 v[108:111], v6 offset:21952
    ds_read_b128 v[112:115], v6 offset:22016
    ds_read_b128 v[116:119], v6 offset:22080
    ds_read_b128 v[120:123], v6 offset:22144
    ds_read_b128 v[124:127], v6 offset:22208
    ds_read_b128 v[128:131], v6 offset:22272
    ds_read_b128 v[132:135], v6 offset:22336
    ds_read_b128 v[136:139], v6 offset:22400
    ds_read_b128 v[140:143], v6 offset:22464
    s_waitcnt lgkmcnt(15)
    v_mfma_f32_16x16x32_bf16 v[148:151], v[80:83], v[16:19], 0
    s_waitcnt lgkmcnt(14)
    v_mfma_f32_16x16x32_bf16 v[148:151], v[84:87], v[20:23], v[148:151]
    s_waitcnt lgkmcnt(13)
    v_mfma_f32_16x16x32_bf16 v[148:151], v[88:91], v[24:27], v[148:151]
    s_waitcnt lgkmcnt(12)
    v_mfma_f32_16x16x32_bf16 v[148:151], v[92:95], v[28:31], v[148:151]
    s_waitcnt lgkmcnt(11)
    v_mfma_f32_16x16x32_bf16 v[148:151], v[96:99], v[32:35], v[148:151]
    s_waitcnt lgkmcnt(10)
    v_mfma_f32_16x16x32_bf16 v[148:151], v[100:103], v[36:39], v[148:151]
    s_waitcnt lgkmcnt(9)
    v_mfma_f32_16x16x32_bf16 v[148:151], v[104:107], v[40:43], v[148:151]
    s_waitcnt lgkmcnt(8)
    v_mfma_f32_16x16x32_bf16 v[148:151], v[108:111], v[44:47], v[148:151]
    s_waitcnt lgkmcnt(7)
    v_mfma_f32_16x16x32_bf16 v[148:151], v[112:115], v[48:51], v[148:151]
    s_waitcnt lgkmcnt(6)
    v_mfma_f32_16x16x32_bf16 v[148:151], v[116:119], v[52:55], v[148:151]
    s_waitcnt lgkmcnt(5)
    v_mfma_f32_16x16x32_bf16 v[148:151], v[120:123], v[56:59], v[148:151]
    s_waitcnt lgkmcnt(4)
    v_mfma_f32_16x16x32_bf16 v[148:151], v[124:127], v[60:63], v[148:151]
    s_waitcnt lgkmcnt(3)
    v_mfma_f32_16x16x32_bf16 v[148:151], v[128:131], v[64:67], v[148:151]
    s_waitcnt lgkmcnt(2)
    v_mfma_f32_16x16x32_bf16 v[148:151], v[132:135], v[68:71], v[148:151]
    s_waitcnt lgkmcnt(1)
    v_mfma_f32_16x16x32_bf16 v[148:151], v[136:139], v[72:75], v[148:151]
    s_waitcnt lgkmcnt(0)
    v_mfma_f32_16x16x32_bf16 v[148:151], v[140:143], v[76:79], v[148:151]
    s_nop 7
    v_max3_f32 v8, v148, v149, v150
    v_max_f32 v8, v8, v151
    v_mov_b32 v9, v8
    s_nop 1
    v_permlane16_swap_b32 v8, v9
    s_nop 0
    v_max_f32 v8, v8, v9
    v_mov_b32 v9, v8
    s_nop 1
    v_permlane32_swap_b32 v8, v9
    s_nop 0
    v_max_f32 v8, v8, v9
    s_mov_b64 exec, 0xffff
    ds_write_b32 v11, v8 offset:4096
    s_mov_b64 exec, -1
    s_waitcnt lgkmcnt(0)
    s_barrier
    ds_read_b32 v12, v10 offset:4096
    ds_read_b32 v13, v10 offset:4160
    ds_read_b32 v14, v10 offset:4224
    ds_read_b32 v15, v10 offset:4288
    s_waitcnt lgkmcnt(0)
    v_max3_f32 v8, v12, v13, v14
    v_max3_f32 v8, v8, v15, v208
    v_sub_f32 v210, v208, v8
    v_sub_f32 v148, v148, v8
    v_sub_f32 v149, v149, v8
    v_sub_f32 v150, v150, v8
    v_sub_f32 v151, v151, v8
    v_exp_f32 v148, v148
    v_exp_f32 v149, v149
    v_exp_f32 v150, v150
    v_exp_f32 v151, v151
    v_exp_f32 v210, v210
    s_nop 0
    v_cvt_pk_bf16_f32 v152, v148, v149
    v_cvt_pk_bf16_f32 v153, v150, v151
    ds_write_b64 v213, v[152:153] offset:0
    v_add_f32 v9, v148, v149
    v_add_f32 v9, v9, v150
    v_add_f32 v9, v9, v151
    v_fmac_f32 v9, v209, v210
    v_mov_b32 v14, v9
    s_nop 1
    v_permlane16_swap_b32 v9, v14
    s_nop 0
    v_add_f32 v9, v9, v14
    v_mov_b32 v14, v9
    s_nop 1
    v_permlane32_swap_b32 v9, v14
    s_nop 0
    v_add_f32 v9, v9, v14
    s_mov_b64 exec, 0xffff
    ds_write_b32 v11, v9 offset:4352
    s_mov_b64 exec, -1
    v_mul_f32 v176, v176, v210
    v_mul_f32 v177, v177, v210
    v_mul_f32 v178, v178, v210
    v_mul_f32 v179, v179, v210
    v_mul_f32 v180, v180, v210
    v_mul_f32 v181, v181, v210
    v_mul_f32 v182, v182, v210
    v_mul_f32 v183, v183, v210
    v_mul_f32 v184, v184, v210
    v_mul_f32 v185, v185, v210
    v_mul_f32 v186, v186, v210
    v_mul_f32 v187, v187, v210
    v_mul_f32 v188, v188, v210
    v_mul_f32 v189, v189, v210
    v_mul_f32 v190, v190, v210
    v_mul_f32 v191, v191, v210
    v_mul_f32 v192, v192, v210
    v_mul_f32 v193, v193, v210
    v_mul_f32 v194, v194, v210
    v_mul_f32 v195, v195, v210
    v_mul_f32 v196, v196, v210
    v_mul_f32 v197, v197, v210
    v_mul_f32 v198, v198, v210
    v_mul_f32 v199, v199, v210
    v_mul_f32 v200, v200, v210
    v_mul_f32 v201, v201, v210
    v_mul_f32 v202, v202, v210
    v_mul_f32 v203, v203, v210
    v_mul_f32 v204, v204, v210
    v_mul_f32 v205, v205, v210
    v_mul_f32 v206, v206, v210
    v_mul_f32 v207, v207, v210
    s_waitcnt lgkmcnt(0)
    s_barrier
    ds_read_b128 v[156:159], v5 offset:0
    ds_read_b128 v[160:163], v5 offset:1024
    ds_read_b64_tr_b16 v[80:81], v211 offset:21504
    ds_read_b64_tr_b16 v[82:83], v211 offset:55296
    ds_read_b64_tr_b16 v[84:85], v211 offset:21536
    ds_read_b64_tr_b16 v[86:87], v211 offset:55328
    ds_read_b64_tr_b16 v[88:89], v211 offset:21568
    ds_read_b64_tr_b16 v[90:91], v211 offset:55360
    ds_read_b64_tr_b16 v[92:93], v211 offset:21600
    ds_read_b64_tr_b16 v[94:95], v211 offset:55392
    ds_read_b64_tr_b16 v[96:97], v211 offset:21632
    ds_read_b64_tr_b16 v[98:99], v211 offset:55424
    ds_read_b64_tr_b16 v[100:101], v211 offset:21664
    ds_read_b64_tr_b16 v[102:103], v211 offset:55456
    ds_read_b64_tr_b16 v[104:105], v211 offset:21696
    ds_read_b64_tr_b16 v[106:107], v211 offset:55488
    ds_read_b64_tr_b16 v[108:109], v211 offset:21728
    ds_read_b64_tr_b16 v[110:111], v211 offset:55520
    s_waitcnt lgkmcnt(8)
    v_mfma_f32_16x16x32_bf16 v[176:179], v[80:83], v[156:159], v[176:179]
    v_mfma_f32_16x16x32_bf16 v[180:183], v[84:87], v[156:159], v[180:183]
    v_mfma_f32_16x16x32_bf16 v[184:187], v[88:91], v[156:159], v[184:187]
    v_mfma_f32_16x16x32_bf16 v[188:191], v[92:95], v[156:159], v[188:191]
    ds_read_b64_tr_b16 v[112:113], v212 offset:21504
    ds_read_b64_tr_b16 v[114:115], v212 offset:55296
    ds_read_b64_tr_b16 v[116:117], v212 offset:21536
    ds_read_b64_tr_b16 v[118:119], v212 offset:55328
    ds_read_b64_tr_b16 v[120:121], v212 offset:21568
    ds_read_b64_tr_b16 v[122:123], v212 offset:55360
    ds_read_b64_tr_b16 v[124:125], v212 offset:21600
    ds_read_b64_tr_b16 v[126:127], v212 offset:55392
    s_waitcnt lgkmcnt(8)
    v_mfma_f32_16x16x32_bf16 v[192:195], v[96:99], v[156:159], v[192:195]
    v_mfma_f32_16x16x32_bf16 v[196:199], v[100:103], v[156:159], v[196:199]
    v_mfma_f32_16x16x32_bf16 v[200:203], v[104:107], v[156:159], v[200:203]
    v_mfma_f32_16x16x32_bf16 v[204:207], v[108:111], v[156:159], v[204:207]
    ds_read_b64_tr_b16 v[128:129], v212 offset:21632
    ds_read_b64_tr_b16 v[130:131], v212 offset:55424
    ds_read_b64_tr_b16 v[132:133], v212 offset:21664
    ds_read_b64_tr_b16 v[134:135], v212 offset:55456
    ds_read_b64_tr_b16 v[136:137], v212 offset:21696
    ds_read_b64_tr_b16 v[138:139], v212 offset:55488
    ds_read_b64_tr_b16 v[140:141], v212 offset:21728
    ds_read_b64_tr_b16 v[142:143], v212 offset:55520
    s_waitcnt lgkmcnt(8)
    v_mfma_f32_16x16x32_bf16 v[176:179], v[112:115], v[160:163], v[176:179]
    v_mfma_f32_16x16x32_bf16 v[180:183], v[116:119], v[160:163], v[180:183]
    v_mfma_f32_16x16x32_bf16 v[184:187], v[120:123], v[160:163], v[184:187]
    v_mfma_f32_16x16x32_bf16 v[188:191], v[124:127], v[160:163], v[188:191]
    s_waitcnt lgkmcnt(0)
    v_mfma_f32_16x16x32_bf16 v[192:195], v[128:131], v[160:163], v[192:195]
    v_mfma_f32_16x16x32_bf16 v[196:199], v[132:135], v[160:163], v[196:199]
    v_mfma_f32_16x16x32_bf16 v[200:203], v[136:139], v[160:163], v[200:203]
    v_mfma_f32_16x16x32_bf16 v[204:207], v[140:143], v[160:163], v[204:207]
    s_lshl_b32 s12, s9, 15
    s_lshl_b32 s13, s8, 10
    s_add_u32 s12, s12, s13
    s_lshl_b32 s13, s3, 8
    s_add_u32 s12, s12, s13
    s_add_u32 s12, s12, 0x100000
    v_lshlrev_b32 v13, 15, v2
    v_lshlrev_b32 v14, 4, v3
    v_add3_u32 v13, v13, v14, s12
    s_nop 3
    v_cvt_pk_bf16_f32 v16, v176, v177
    v_cvt_pk_bf16_f32 v17, v178, v179
    v_cvt_pk_bf16_f32 v18, v180, v181
    v_cvt_pk_bf16_f32 v19, v182, v183
    v_cvt_pk_bf16_f32 v20, v184, v185
    v_cvt_pk_bf16_f32 v21, v186, v187
    v_cvt_pk_bf16_f32 v22, v188, v189
    v_cvt_pk_bf16_f32 v23, v190, v191
    v_cvt_pk_bf16_f32 v24, v192, v193
    v_cvt_pk_bf16_f32 v25, v194, v195
    v_cvt_pk_bf16_f32 v26, v196, v197
    v_cvt_pk_bf16_f32 v27, v198, v199
    v_cvt_pk_bf16_f32 v28, v200, v201
    v_cvt_pk_bf16_f32 v29, v202, v203
    v_cvt_pk_bf16_f32 v30, v204, v205
    v_cvt_pk_bf16_f32 v31, v206, v207
    buffer_store_dwordx4 v[16:19], v13, s[48:51], 0 offen offset:0
    buffer_store_dwordx4 v[20:23], v13, s[48:51], 0 offen offset:64
    buffer_store_dwordx4 v[24:27], v13, s[48:51], 0 offen offset:128
    buffer_store_dwordx4 v[28:31], v13, s[48:51], 0 offen offset:192
    s_cmp_lg_u32 s3, 0
    s_cbranch_scc1 k2_end
    ds_read_b32 v40, v10 offset:4352
    ds_read_b32 v41, v10 offset:4416
    ds_read_b32 v42, v10 offset:4480
    ds_read_b32 v43, v10 offset:4544
    s_lshl_b32 s12, s9, 8
    s_lshl_b32 s13, s8, 3
    s_add_u32 s12, s12, s13
    s_add_u32 s12, s12, 0xc0000
    v_lshlrev_b32 v13, 8, v2
    v_add_u32 v13, s12, v13
    s_waitcnt lgkmcnt(0)
    v_add_f32 v40, v40, v41
    v_add_f32 v42, v42, v43
    v_add_f32 v9, v40, v42
    s_mov_b64 exec, 0xffff
    buffer_store_dwordx2 v[8:9], v13, s[48:51], 0 offen
k2_end:
    s_endpgm
.globl k3_kernel
.p2align 8
.type k3_kernel,@function
k3_kernel:
    s_cmp_ge_u32 s2, 312
    s_cbranch_scc1 k3_end
    s_load_dwordx16 s[16:31], s[0:1], 0
    s_load_dwordx8 s[32:39], s[0:1], 64
    s_load_dwordx2 s[40:41], s[0:1], 96
    v_lshrrev_b32 v3, 6, v0
    v_and_b32 v1, 63, v0
    v_readfirstlane_b32 s3, v3
    v_and_b32 v2, 15, v1
    v_lshrrev_b32 v3, 4, v1
    s_mov_b32 s14, 0x05040100
    s_mov_b32 s15, 0x07060302
    s_waitcnt lgkmcnt(0)
    s_mov_b32 s44, s40
    s_and_b32 s45, s41, 0xffff
    s_mov_b32 s46, 0x800000
    s_mov_b32 s47, 0x20000
    s_cmp_ge_u32 s2, 256
    s_cbranch_scc1 k3_ffn
    s_and_b32 s4, s2, 7
    s_lshr_b32 s5, s2, 3
    s_lshr_b32 s6, s5, 3
    s_lshl_b32 s4, s4, 2
    s_add_u32 s6, s6, s4
    s_lshr_b32 s7, s5, 1
    s_and_b32 s7, s7, 3
    s_and_b32 s8, s5, 1
    s_mov_b32 s48, s24
    s_and_b32 s49, s25, 0xffff
    s_mov_b32 s50, 0x400000
    s_mov_b32 s51, 0x20000
    s_mov_b32 s52, s26
    s_and_b32 s53, s27, 0xffff
    s_mov_b32 s54, 0x400000
    s_mov_b32 s55, 0x20000
    s_mov_b32 s13, 4096
    s_lshl_b32 s9, s3, 5
    s_add_u32 s9, s9, s6
    s_lshl_b32 s10, s9, 8
    s_add_u32 s10, s10, 0xc0000
    v_lshlrev_b32 v4, 6, v3
    v_add_u32 v4, s10, v4
    buffer_load_dwordx4 v[16:19], v4, s[44:47], 0 offen offset:0
    buffer_load_dwordx4 v[20:23], v4, s[44:47], 0 offen offset:16
    buffer_load_dwordx4 v[24:27], v4, s[44:47], 0 offen offset:32
    buffer_load_dwordx4 v[28:31], v4, s[44:47], 0 offen offset:48
    s_lshl_b32 s10, s9, 15
    s_lshl_b32 s11, s7, 8
    s_add_u32 s10, s10, s11
    s_add_u32 s10, s10, 0x100000
    v_lshlrev_b32 v4, 13, v3
    v_lshlrev_b32 v5, 4, v2
    v_add3_u32 v4, v4, v5, s10
    buffer_load_dwordx4 v[32:35], v4, s[44:47], 0 offen offset:0
    buffer_load_dwordx4 v[36:39], v4, s[44:47], 0 offen offset:1024
    buffer_load_dwordx4 v[40:43], v4, s[44:47], 0 offen offset:2048
    buffer_load_dwordx4 v[44:47], v4, s[44:47], 0 offen offset:3072
    buffer_load_dwordx4 v[48:51], v4, s[44:47], s13 offen offset:0
    buffer_load_dwordx4 v[52:55], v4, s[44:47], s13 offen offset:1024
    buffer_load_dwordx4 v[56:59], v4, s[44:47], s13 offen offset:2048
    buffer_load_dwordx4 v[60:63], v4, s[44:47], s13 offen offset:3072
    s_lshl_b32 s10, s7, 20
    s_lshl_b32 s11, s3, 18
    s_add_u32 s10, s10, s11
    s_lshl_b32 s11, s6, 8
    s_add_u32 s10, s10, s11
    v_lshlrev_b32 v4, 15, v3
    v_add3_u32 v4, v4, v5, s10
    s_mov_b32 s12, 0x0
    buffer_load_dwordx4 v[64:67], v4, s[48:51], s12 offen
    s_mov_b32 s12, 0x2000
    buffer_load_dwordx4 v[68:71], v4, s[48:51], s12 offen
    s_mov_b32 s12, 0x4000
    buffer_load_dwordx4 v[72:75], v4, s[48:51], s12 offen
    s_mov_b32 s12, 0x6000
    buffer_load_dwordx4 v[76:79], v4, s[48:51], s12 offen
    s_mov_b32 s12, 0x20000
    buffer_load_dwordx4 v[80:83], v4, s[48:51], s12 offen
    s_mov_b32 s12, 0x22000
    buffer_load_dwordx4 v[84:87], v4, s[48:51], s12 offen
    s_mov_b32 s12, 0x24000
    buffer_load_dwordx4 v[88:91], v4, s[48:51], s12 offen
    s_mov_b32 s12, 0x26000
    buffer_load_dwordx4 v[92:95], v4, s[48:51], s12 offen
    s_lshl_b32 s10, s6, 17
    s_lshl_b32 s11, s3, 15
    s_add_u32 s10, s10, s11
    s_lshl_b32 s11, s8, 9
    s_add_u32 s10, s10, s11
    v_lshlrev_b32 v4, 13, v3
    v_add3_u32 v4, v4, v5, s10
    buffer_load_dwordx4 v[96:99], v4, s[52:55], 0 offen offset:0
    buffer_load_dwordx4 v[100:103], v4, s[52:55], 0 offen offset:1024
    buffer_load_dwordx4 v[104:107], v4, s[52:55], 0 offen offset:2048
    buffer_load_dwordx4 v[108:111], v4, s[52:55], 0 offen offset:3072
    buffer_load_dwordx4 v[112:115], v4, s[52:55], s13 offen offset:0
    buffer_load_dwordx4 v[116:119], v4, s[52:55], s13 offen offset:1024
    buffer_load_dwordx4 v[120:123], v4, s[52:55], s13 offen offset:2048
    buffer_load_dwordx4 v[124:127], v4, s[52:55], s13 offen offset:3072
    buffer_load_dwordx4 v[128:131], v4, s[52:55], 0 offen offset:256
    buffer_load_dwordx4 v[132:135], v4, s[52:55], 0 offen offset:1280
    buffer_load_dwordx4 v[136:139], v4, s[52:55], 0 offen offset:2304
    buffer_load_dwordx4 v[140:143], v4, s[52:55], 0 offen offset:3328
    buffer_load_dwordx4 v[144:147], v4, s[52:55], s13 offen offset:256
    buffer_load_dwordx4 v[148:151], v4, s[52:55], s13 offen offset:1280
    buffer_load_dwordx4 v[152:155], v4, s[52:55], s13 offen offset:2304
    buffer_load_dwordx4 v[156:159], v4, s[52:55], s13 offen offset:3328
    s_waitcnt vmcnt(32)
    v_max3_f32 v6, v16, v18, v20
    v_max3_f32 v6, v6, v22, v24
    v_max3_f32 v6, v6, v26, v28
    v_max_f32 v6, v6, v30
    v_mov_b32 v7, v6
    s_nop 1
    v_permlane16_swap_b32 v6, v7
    s_nop 0
    v_max_f32 v6, v6, v7
    v_mov_b32 v7, v6
    s_nop 1
    v_permlane32_swap_b32 v6, v7
    s_nop 0
    v_max_f32 v6, v6, v7
    v_sub_f32 v16, v16, v6
    v_sub_f32 v18, v18, v6
    v_sub_f32 v20, v20, v6
    v_sub_f32 v22, v22, v6
    v_sub_f32 v24, v24, v6
    v_sub_f32 v26, v26, v6
    v_sub_f32 v28, v28, v6
    v_sub_f32 v30, v30, v6
    v_exp_f32 v16, v16
    v_exp_f32 v18, v18
    v_exp_f32 v20, v20
    v_exp_f32 v22, v22
    v_exp_f32 v24, v24
    v_exp_f32 v26, v26
    v_exp_f32 v28, v28
    v_exp_f32 v30, v30
    s_nop 0
    v_mul_f32 v7, v16, v17
    v_fma_f32 v7, v18, v19, v7
    v_fma_f32 v7, v20, v21, v7
    v_fma_f32 v7, v22, v23, v7
    v_fma_f32 v7, v24, v25, v7
    v_fma_f32 v7, v26, v27, v7
    v_fma_f32 v7, v28, v29, v7
    v_fma_f32 v7, v30, v31, v7
    v_mov_b32 v8, v7
    s_nop 1
    v_permlane16_swap_b32 v7, v8
    s_nop 0
    v_add_f32 v7, v7, v8
    v_mov_b32 v8, v7
    s_nop 1
    v_permlane32_swap_b32 v7, v8
    s_nop 0
    v_add_f32 v7, v7, v8
    v_rcp_f32 v7, v7
    s_nop 0
    v_mul_f32 v16, v16, v7
    v_mul_f32 v18, v18, v7
    v_mul_f32 v20, v20, v7
    v_mul_f32 v22, v22, v7
    v_mul_f32 v24, v24, v7
    v_mul_f32 v26, v26, v7
    v_mul_f32 v28, v28, v7
    v_mul_f32 v30, v30, v7
    v_cvt_pk_bf16_f32 v8, v16, v18
    v_cvt_pk_bf16_f32 v9, v20, v22
    v_cvt_pk_bf16_f32 v10, v24, v26
    v_cvt_pk_bf16_f32 v11, v28, v30
    s_waitcnt vmcnt(24)
    v_perm_b32 v160, v36, v32, s14
    v_perm_b32 v161, v44, v40, s14
    v_perm_b32 v162, v52, v48, s14
    v_perm_b32 v163, v60, v56, s14
    v_perm_b32 v164, v36, v32, s15
    v_perm_b32 v165, v44, v40, s15
    v_perm_b32 v166, v52, v48, s15
    v_perm_b32 v167, v60, v56, s15
    v_mfma_f32_16x16x32_bf16 v[192:195], v[8:11], v[160:163], 0
    v_perm_b32 v168, v37, v33, s14
    v_perm_b32 v169, v45, v41, s14
    v_perm_b32 v170, v53, v49, s14
    v_perm_b32 v171, v61, v57, s14
    v_mfma_f32_16x16x32_bf16 v[196:199], v[8:11], v[164:167], 0
    v_perm_b32 v172, v37, v33, s15
    v_perm_b32 v173, v45, v41, s15
    v_perm_b32 v174, v53, v49, s15
    v_perm_b32 v175, v61, v57, s15
    v_mfma_f32_16x16x32_bf16 v[200:203], v[8:11], v[168:171], 0
    v_perm_b32 v176, v38, v34, s14
    v_perm_b32 v177, v46, v42, s14
    v_perm_b32 v178, v54, v50, s14
    v_perm_b32 v179, v62, v58, s14
    v_mfma_f32_16x16x32_bf16 v[204:207], v[8:11], v[172:175], 0
    v_perm_b32 v180, v38, v34, s15
    v_perm_b32 v181, v46, v42, s15
    v_perm_b32 v182, v54, v50, s15
    v_perm_b32 v183, v62, v58, s15
    v_mfma_f32_16x16x32_bf16 v[208:211], v[8:11], v[176:179], 0
    v_perm_b32 v184, v39, v35, s14
    v_perm_b32 v185, v47, v43, s14
    v_perm_b32 v186, v55, v51, s14
    v_perm_b32 v187, v63, v59, s14
    v_mfma_f32_16x16x32_bf16 v[212:215], v[8:11], v[180:183], 0
    v_perm_b32 v188, v39, v35, s15
    v_perm_b32 v189, v47, v43, s15
    v_perm_b32 v190, v55, v51, s15
    v_perm_b32 v191, v63, v59, s15
    v_mfma_f32_16x16x32_bf16 v[216:219], v[8:11], v[184:187], 0
    s_nop 1
    v_mfma_f32_16x16x32_bf16 v[220:223], v[8:11], v[188:191], 0
    s_nop 7
    v_cvt_pk_bf16_f32 v16, v192, v196
    v_cvt_pk_bf16_f32 v17, v200, v204
    v_cvt_pk_bf16_f32 v18, v208, v212
    v_cvt_pk_bf16_f32 v19, v216, v220
    s_mul_i32 s10, s3, 320
    v_add_u32 v4, s10, v5
    s_mov_b64 exec, 0xffff
    ds_write_b128 v4, v[16:19] offset:0
    s_mov_b64 exec, -1
    s_waitcnt lgkmcnt(0)
    s_barrier
    v_and_b32 v6, 3, v1
    v_mul_u32_u24 v6, 320, v6
    v_lshl_add_u32 v6, v3, 4, v6
    s_lshl_b32 s10, s3, 6
    v_add_u32 v6, s10, v6
    ds_read_b128 v[8:11], v6 offset:0
    s_waitcnt vmcnt(16) lgkmcnt(0)
    v_perm_b32 v160, v68, v64, s14
    v_perm_b32 v161, v76, v72, s14
    v_perm_b32 v162, v84, v80, s14
    v_perm_b32 v163, v92, v88, s14
    v_perm_b32 v164, v68, v64, s15
    v_perm_b32 v165, v76, v72, s15
    v_perm_b32 v166, v84, v80, s15
    v_perm_b32 v167, v92, v88, s15
    v_mfma_f32_16x16x32_bf16 v[192:195], v[8:11], v[160:163], 0
    v_perm_b32 v168, v69, v65, s14
    v_perm_b32 v169, v77, v73, s14
    v_perm_b32 v170, v85, v81, s14
    v_perm_b32 v171, v93, v89, s14
    v_mfma_f32_16x16x32_bf16 v[196:199], v[8:11], v[164:167], 0
    v_perm_b32 v172, v69, v65, s15
    v_perm_b32 v173, v77, v73, s15
    v_perm_b32 v174, v85, v81, s15
    v_perm_b32 v175, v93, v89, s15
    v_mfma_f32_16x16x32_bf16 v[200:203], v[8:11], v[168:171], 0
    v_perm_b32 v176, v70, v66, s14
    v_perm_b32 v177, v78, v74, s14
    v_perm_b32 v178, v86, v82, s14
    v_perm_b32 v179, v94, v90, s14
    v_mfma_f32_16x16x32_bf16 v[204:207], v[8:11], v[172:175], 0
    v_perm_b32 v180, v70, v66, s15
    v_perm_b32 v181, v78, v74, s15
    v_perm_b32 v182, v86, v82, s15
    v_perm_b32 v183, v94, v90, s15
    v_mfma_f32_16x16x32_bf16 v[208:211], v[8:11], v[176:179], 0
    v_perm_b32 v184, v71, v67, s14
    v_perm_b32 v185, v79, v75, s14
    v_perm_b32 v186, v87, v83, s14
    v_perm_b32 v187, v95, v91, s14
    v_mfma_f32_16x16x32_bf16 v[212:215], v[8:11], v[180:183], 0
    v_perm_b32 v188, v71, v67, s15
    v_perm_b32 v189, v79, v75, s15
    v_perm_b32 v190, v87, v83, s15
    v_perm_b32 v191, v95, v91, s15
    v_mfma_f32_16x16x32_bf16 v[216:219], v[8:11], v[184:187], 0
    s_nop 1
    v_mfma_f32_16x16x32_bf16 v[220:223], v[8:11], v[188:191], 0
    s_nop 7
    s_lshl_b32 s10, s3, 12
    v_add_u32 v4, s10, v5
    s_mov_b64 exec, 0xffff
    ds_write_b128 v4, v[192:195] offset:1280
    ds_write_b128 v4, v[196:199] offset:1536
    ds_write_b128 v4, v[200:203] offset:1792
    ds_write_b128 v4, v[204:207] offset:2048
    ds_write_b128 v4, v[208:211] offset:2304
    ds_write_b128 v4, v[212:215] offset:2560
    ds_write_b128 v4, v[216:219] offset:2816
    ds_write_b128 v4, v[220:223] offset:3072
    s_mov_b64 exec, -1
    s_waitcnt lgkmcnt(0)
    s_barrier
    s_cmp_ge_u32 s3, 2
    s_cbranch_scc1 k3_sumdone
    v_lshlrev_b32 v7, 4, v0
    ds_read_b128 v[16:19], v7 offset:1280
    ds_read_b128 v[20:23], v7 offset:5376
    ds_read_b128 v[24:27], v7 offset:9472
    ds_read_b128 v[28:31], v7 offset:13568
    v_lshrrev_b32 v12, 4, v0
    v_lshlrev_b32 v13, 4, v2
    v_lshl_add_u32 v12, v12, 1, v13
    s_waitcnt lgkmcnt(0)
    v_add_f32 v16, v16, v20
    v_add_f32 v24, v24, v28
    v_add_f32 v17, v17, v21
    v_add_f32 v25, v25, v29
    v_add_f32 v18, v18, v22
    v_add_f32 v26, v26, v30
    v_add_f32 v19, v19, v23
    v_add_f32 v27, v27, v31
    v_add_f32 v16, v16, v24
    v_add_f32 v17, v17, v25
    v_add_f32 v18, v18, v26
    v_add_f32 v19, v19, v27
    v_cvt_pk_bf16_f32 v20, v16, v17
    v_cvt_pk_bf16_f32 v21, v18, v19
    ds_write_b16 v12, v20 offset:17664
    ds_write_b16_d16_hi v12, v20 offset:17984
    ds_write_b16 v12, v21 offset:18304
    ds_write_b16_d16_hi v12, v21 offset:18624
    s_waitcnt lgkmcnt(0)
k3_sumdone:
    s_barrier
    ds_read_b128 v[8:11], v6 offset:17664
    s_waitcnt vmcnt(8) lgkmcnt(0)
    v_perm_b32 v160, v100, v96, s14
    v_perm_b32 v161, v108, v104, s14
    v_perm_b32 v162, v116, v112, s14
    v_perm_b32 v163, v124, v120, s14
    v_perm_b32 v164, v100, v96, s15
    v_perm_b32 v165, v108, v104, s15
    v_perm_b32 v166, v116, v112, s15
    v_perm_b32 v167, v124, v120, s15
    v_mfma_f32_16x16x32_bf16 v[192:195], v[8:11], v[160:163], 0
    v_perm_b32 v168, v101, v97, s14
    v_perm_b32 v169, v109, v105, s14
    v_perm_b32 v170, v117, v113, s14
    v_perm_b32 v171, v125, v121, s14
    v_mfma_f32_16x16x32_bf16 v[196:199], v[8:11], v[164:167], 0
    v_perm_b32 v172, v101, v97, s15
    v_perm_b32 v173, v109, v105, s15
    v_perm_b32 v174, v117, v113, s15
    v_perm_b32 v175, v125, v121, s15
    v_mfma_f32_16x16x32_bf16 v[200:203], v[8:11], v[168:171], 0
    v_perm_b32 v176, v102, v98, s14
    v_perm_b32 v177, v110, v106, s14
    v_perm_b32 v178, v118, v114, s14
    v_perm_b32 v179, v126, v122, s14
    v_mfma_f32_16x16x32_bf16 v[204:207], v[8:11], v[172:175], 0
    v_perm_b32 v180, v102, v98, s15
    v_perm_b32 v181, v110, v106, s15
    v_perm_b32 v182, v118, v114, s15
    v_perm_b32 v183, v126, v122, s15
    v_mfma_f32_16x16x32_bf16 v[208:211], v[8:11], v[176:179], 0
    v_perm_b32 v184, v103, v99, s14
    v_perm_b32 v185, v111, v107, s14
    v_perm_b32 v186, v119, v115, s14
    v_perm_b32 v187, v127, v123, s14
    v_mfma_f32_16x16x32_bf16 v[212:215], v[8:11], v[180:183], 0
    v_perm_b32 v188, v103, v99, s15
    v_perm_b32 v189, v111, v107, s15
    v_perm_b32 v190, v119, v115, s15
    v_perm_b32 v191, v127, v123, s15
    v_mfma_f32_16x16x32_bf16 v[216:219], v[8:11], v[184:187], 0
    s_nop 1
    v_mfma_f32_16x16x32_bf16 v[220:223], v[8:11], v[188:191], 0
    s_waitcnt vmcnt(0)
    v_perm_b32 v96, v132, v128, s14
    v_perm_b32 v97, v140, v136, s14
    v_perm_b32 v98, v148, v144, s14
    v_perm_b32 v99, v156, v152, s14
    v_perm_b32 v100, v132, v128, s15
    v_perm_b32 v101, v140, v136, s15
    v_perm_b32 v102, v148, v144, s15
    v_perm_b32 v103, v156, v152, s15
    v_mfma_f32_16x16x32_bf16 v[224:227], v[8:11], v[96:99], 0
    v_perm_b32 v104, v133, v129, s14
    v_perm_b32 v105, v141, v137, s14
    v_perm_b32 v106, v149, v145, s14
    v_perm_b32 v107, v157, v153, s14
    v_mfma_f32_16x16x32_bf16 v[228:231], v[8:11], v[100:103], 0
    v_perm_b32 v108, v133, v129, s15
    v_perm_b32 v109, v141, v137, s15
    v_perm_b32 v110, v149, v145, s15
    v_perm_b32 v111, v157, v153, s15
    v_mfma_f32_16x16x32_bf16 v[232:235], v[8:11], v[104:107], 0
    v_perm_b32 v112, v134, v130, s14
    v_perm_b32 v113, v142, v138, s14
    v_perm_b32 v114, v150, v146, s14
    v_perm_b32 v115, v158, v154, s14
    v_mfma_f32_16x16x32_bf16 v[236:239], v[8:11], v[108:111], 0
    v_perm_b32 v116, v134, v130, s15
    v_perm_b32 v117, v142, v138, s15
    v_perm_b32 v118, v150, v146, s15
    v_perm_b32 v119, v158, v154, s15
    v_mfma_f32_16x16x32_bf16 v[240:243], v[8:11], v[112:115], 0
    v_perm_b32 v120, v135, v131, s14
    v_perm_b32 v121, v143, v139, s14
    v_perm_b32 v122, v151, v147, s14
    v_perm_b32 v123, v159, v155, s14
    v_mfma_f32_16x16x32_bf16 v[244:247], v[8:11], v[116:119], 0
    v_perm_b32 v124, v135, v131, s15
    v_perm_b32 v125, v143, v139, s15
    v_perm_b32 v126, v151, v147, s15
    v_perm_b32 v127, v159, v155, s15
    v_mfma_f32_16x16x32_bf16 v[248:251], v[8:11], v[120:123], 0
    s_nop 1
    v_mfma_f32_16x16x32_bf16 v[252:255], v[8:11], v[124:127], 0
    s_nop 7
    s_mov_b64 exec, 0xffff
    ds_write_b128 v4, v[192:195] offset:1280
    ds_write_b128 v4, v[196:199] offset:1536
    ds_write_b128 v4, v[200:203] offset:1792
    ds_write_b128 v4, v[204:207] offset:2048
    ds_write_b128 v4, v[208:211] offset:2304
    ds_write_b128 v4, v[212:215] offset:2560
    ds_write_b128 v4, v[216:219] offset:2816
    ds_write_b128 v4, v[220:223] offset:3072
    ds_write_b128 v4, v[224:227] offset:3328
    ds_write_b128 v4, v[228:231] offset:3584
    ds_write_b128 v4, v[232:235] offset:3840
    ds_write_b128 v4, v[236:239] offset:4096
    ds_write_b128 v4, v[240:243] offset:4352
    ds_write_b128 v4, v[244:247] offset:4608
    ds_write_b128 v4, v[248:251] offset:4864
    ds_write_b128 v4, v[252:255] offset:5120
    s_mov_b64 exec, -1
    s_waitcnt lgkmcnt(0)
    s_barrier
    v_lshlrev_b32 v7, 4, v0
    ds_read_b128 v[16:19], v7 offset:1280
    ds_read_b128 v[20:23], v7 offset:5376
    ds_read_b128 v[24:27], v7 offset:9472
    ds_read_b128 v[28:31], v7 offset:13568
    s_lshl_b32 s10, s6, 2
    s_add_u32 s10, s10, s7
    s_lshl_b32 s10, s10, 13
    s_lshl_b32 s11, s8, 12
    s_add_u32 s10, s10, s11
    s_add_u32 s10, s10, 0x600000
    v_add_u32 v12, s10, v7
    s_waitcnt lgkmcnt(0)
    v_add_f32 v16, v16, v20
    v_add_f32 v24, v24, v28
    v_add_f32 v17, v17, v21
    v_add_f32 v25, v25, v29
    v_add_f32 v18, v18, v22
    v_add_f32 v26, v26, v30
    v_add_f32 v19, v19, v23
    v_add_f32 v27, v27, v31
    v_add_f32 v16, v16, v24
    v_add_f32 v17, v17, v25
    v_add_f32 v18, v18, v26
    v_add_f32 v19, v19, v27
    buffer_store_dwordx4 v[16:19], v12, s[44:47], 0 offen
    s_endpgm
k3_ffn:
    s_sub_u32 s4, s2, 256
    s_mov_b32 s52, s34
    s_and_b32 s53, s35, 0xffff
    s_mov_b32 s54, 0x1c0000
    s_mov_b32 s55, 0x20000
    s_mov_b32 s13, 4096
    v_and_b32 v4, 31, v1
    v_lshrrev_b32 v5, 5, v1
    v_mul_u32_u24 v5, 14336, v5
    s_lshl_b32 s10, s4, 5
    v_add3_u32 v5, v5, v4, s10
    v_lshlrev_b32 v5, 4, v5
    v_add_u32 v5, 0x40000, v5
    s_mov_b32 s12, 0x0
    buffer_load_dwordx4 v[16:19], v5, s[44:47], s12 offen
    s_mov_b32 s12, 0x7000
    buffer_load_dwordx4 v[20:23], v5, s[44:47], s12 offen
    s_mov_b32 s12, 0xe000
    buffer_load_dwordx4 v[24:27], v5, s[44:47], s12 offen
    s_mov_b32 s12, 0x15000
    buffer_load_dwordx4 v[28:31], v5, s[44:47], s12 offen
    s_mov_b32 s12, 0x1c000
    buffer_load_dwordx4 v[32:35], v5, s[44:47], s12 offen
    s_mov_b32 s12, 0x23000
    buffer_load_dwordx4 v[36:39], v5, s[44:47], s12 offen
    s_mov_b32 s12, 0x2a000
    buffer_load_dwordx4 v[40:43], v5, s[44:47], s12 offen
    s_mov_b32 s12, 0x31000
    buffer_load_dwordx4 v[44:47], v5, s[44:47], s12 offen
    s_lshl_b32 s10, s4, 15
    s_lshl_b32 s11, s3, 8
    s_add_u32 s10, s10, s11
    v_lshlrev_b32 v6, 13, v3
    v_lshlrev_b32 v7, 4, v2
    v_add3_u32 v6, v6, v7, s10
    buffer_load_dwordx4 v[64:67], v6, s[52:55], 0 offen offset:0
    buffer_load_dwordx4 v[68:71], v6, s[52:55], 0 offen offset:1024
    buffer_load_dwordx4 v[72:75], v6, s[52:55], 0 offen offset:2048
    buffer_load_dwordx4 v[76:79], v6, s[52:55], 0 offen offset:3072
    buffer_load_dwordx4 v[80:83], v6, s[52:55], s13 offen offset:0
    buffer_load_dwordx4 v[84:87], v6, s[52:55], s13 offen offset:1024
    buffer_load_dwordx4 v[88:91], v6, s[52:55], s13 offen offset:2048
    buffer_load_dwordx4 v[92:95], v6, s[52:55], s13 offen offset:3072
    s_waitcnt vmcnt(8)
    v_add_f32 v16, v16, v24
    v_add_f32 v32, v32, v40
    v_add_f32 v17, v17, v25
    v_add_f32 v33, v33, v41
    v_add_f32 v18, v18, v26
    v_add_f32 v34, v34, v42
    v_add_f32 v19, v19, v27
    v_add_f32 v35, v35, v43
    v_add_f32 v20, v20, v28
    v_add_f32 v36, v36, v44
    v_add_f32 v21, v21, v29
    v_add_f32 v37, v37, v45
    v_add_f32 v22, v22, v30
    v_add_f32 v38, v38, v46
    v_add_f32 v23, v23, v31
    v_add_f32 v39, v39, v47
    v_add_f32 v16, v16, v32
    v_add_f32 v17, v17, v33
    v_add_f32 v18, v18, v34
    v_add_f32 v19, v19, v35
    v_add_f32 v20, v20, v36
    v_add_f32 v21, v21, v37
    v_add_f32 v22, v22, v38
    v_add_f32 v23, v23, v39
    v_mov_b32 v24, v16
    v_mov_b32 v25, v17
    v_mov_b32 v26, v18
    v_mov_b32 v27, v19
    v_mov_b32 v28, v20
    v_mov_b32 v29, v21
    v_mov_b32 v30, v22
    v_mov_b32 v31, v23
    s_nop 1
    v_permlane32_swap_b32 v16, v24
    v_permlane32_swap_b32 v17, v25
    v_permlane32_swap_b32 v18, v26
    v_permlane32_swap_b32 v19, v27
    v_permlane32_swap_b32 v20, v28
    v_permlane32_swap_b32 v21, v29
    v_permlane32_swap_b32 v22, v30
    v_permlane32_swap_b32 v23, v31
    s_nop 0
    v_add_f32 v16, v16, v24
    v_add_f32 v17, v17, v25
    v_add_f32 v18, v18, v26
    v_add_f32 v19, v19, v27
    v_add_f32 v20, v20, v28
    v_add_f32 v21, v21, v29
    v_add_f32 v22, v22, v30
    v_add_f32 v23, v23, v31
    v_cvt_pk_bf16_f32 v24, v16, v17
    v_cvt_pk_bf16_f32 v25, v18, v19
    v_cvt_pk_bf16_f32 v26, v20, v21
    v_cvt_pk_bf16_f32 v27, v22, v23
    v_lshlrev_b32 v16, 16, v24
    v_and_b32 v17, 0xffff0000, v24
    v_lshlrev_b32 v18, 16, v25
    v_and_b32 v19, 0xffff0000, v25
    v_lshlrev_b32 v20, 16, v26
    v_and_b32 v21, 0xffff0000, v26
    v_lshlrev_b32 v22, 16, v27
    v_and_b32 v23, 0xffff0000, v27
    v_mul_f32 v28, 0xbfb8aa3b, v16
    v_exp_f32 v28, v28
    s_nop 0
    v_add_f32 v28, 1.0, v28
    v_rcp_f32 v28, v28
    s_nop 0
    v_mul_f32 v16, v16, v28
    v_mul_f32 v29, 0xbfb8aa3b, v17
    v_exp_f32 v29, v29
    s_nop 0
    v_add_f32 v29, 1.0, v29
    v_rcp_f32 v29, v29
    s_nop 0
    v_mul_f32 v17, v17, v29
    v_mul_f32 v30, 0xbfb8aa3b, v18
    v_exp_f32 v30, v30
    s_nop 0
    v_add_f32 v30, 1.0, v30
    v_rcp_f32 v30, v30
    s_nop 0
    v_mul_f32 v18, v18, v30
    v_mul_f32 v31, 0xbfb8aa3b, v19
    v_exp_f32 v31, v31
    s_nop 0
    v_add_f32 v31, 1.0, v31
    v_rcp_f32 v31, v31
    s_nop 0
    v_mul_f32 v19, v19, v31
    v_cvt_pk_bf16_f32 v24, v16, v17
    v_cvt_pk_bf16_f32 v25, v18, v19
    v_lshlrev_b32 v16, 16, v24
    v_and_b32 v17, 0xffff0000, v24
    v_lshlrev_b32 v18, 16, v25
    v_and_b32 v19, 0xffff0000, v25
    v_mul_f32 v16, v16, v20
    v_mul_f32 v17, v17, v21
    v_mul_f32 v18, v18, v22
    v_mul_f32 v19, v19, v23
    v_cvt_pk_bf16_f32 v24, v16, v17
    v_cvt_pk_bf16_f32 v25, v18, v19
    s_mul_i32 s10, s3, 320
    v_lshlrev_b32 v8, 1, v4
    v_add_u32 v8, s10, v8
    ds_write_b16 v8, v24 offset:18944
    ds_write_b16_d16_hi v8, v24 offset:19024
    ds_write_b16 v8, v25 offset:19104
    ds_write_b16_d16_hi v8, v25 offset:19184
    v_and_b32 v9, 3, v1
    v_mul_u32_u24 v9, 80, v9
    v_lshl_add_u32 v9, v3, 4, v9
    v_add_u32 v9, s10, v9
    s_waitcnt lgkmcnt(0)
    ds_read_b128 v[8:11], v9 offset:18944
    s_waitcnt vmcnt(0) lgkmcnt(0)
    v_perm_b32 v96, v68, v64, s14
    v_perm_b32 v97, v76, v72, s14
    v_perm_b32 v98, v84, v80, s14
    v_perm_b32 v99, v92, v88, s14
    v_perm_b32 v100, v68, v64, s15
    v_perm_b32 v101, v76, v72, s15
    v_perm_b32 v102, v84, v80, s15
    v_perm_b32 v103, v92, v88, s15
    v_mfma_f32_16x16x32_bf16 v[128:131], v[8:11], v[96:99], 0
    v_perm_b32 v104, v69, v65, s14
    v_perm_b32 v105, v77, v73, s14
    v_perm_b32 v106, v85, v81, s14
    v_perm_b32 v107, v93, v89, s14
    v_mfma_f32_16x16x32_bf16 v[132:135], v[8:11], v[100:103], 0
    v_perm_b32 v108, v69, v65, s15
    v_perm_b32 v109, v77, v73, s15
    v_perm_b32 v110, v85, v81, s15
    v_perm_b32 v111, v93, v89, s15
    v_mfma_f32_16x16x32_bf16 v[136:139], v[8:11], v[104:107], 0
    v_perm_b32 v112, v70, v66, s14
    v_perm_b32 v113, v78, v74, s14
    v_perm_b32 v114, v86, v82, s14
    v_perm_b32 v115, v94, v90, s14
    v_mfma_f32_16x16x32_bf16 v[140:143], v[8:11], v[108:111], 0
    v_perm_b32 v116, v70, v66, s15
    v_perm_b32 v117, v78, v74, s15
    v_perm_b32 v118, v86, v82, s15
    v_perm_b32 v119, v94, v90, s15
    v_mfma_f32_16x16x32_bf16 v[144:147], v[8:11], v[112:115], 0
    v_perm_b32 v120, v71, v67, s14
    v_perm_b32 v121, v79, v75, s14
    v_perm_b32 v122, v87, v83, s14
    v_perm_b32 v123, v95, v91, s14
    v_mfma_f32_16x16x32_bf16 v[148:151], v[8:11], v[116:119], 0
    v_perm_b32 v124, v71, v67, s15
    v_perm_b32 v125, v79, v75, s15
    v_perm_b32 v126, v87, v83, s15
    v_perm_b32 v127, v95, v91, s15
    v_mfma_f32_16x16x32_bf16 v[152:155], v[8:11], v[120:123], 0
    s_nop 1
    v_mfma_f32_16x16x32_bf16 v[156:159], v[8:11], v[124:127], 0
    s_lshl_b32 s10, s4, 13
    s_lshl_b32 s11, s3, 11
    s_add_u32 s10, s10, s11
    s_add_u32 s10, s10, 0x700000
    v_add_u32 v4, s10, v7
    s_nop 7
    s_mov_b64 exec, 0xffff
    buffer_store_dwordx4 v[128:131], v4, s[44:47], 0 offen offset:0
    buffer_store_dwordx4 v[132:135], v4, s[44:47], 0 offen offset:256
    buffer_store_dwordx4 v[136:139], v4, s[44:47], 0 offen offset:512
    buffer_store_dwordx4 v[140:143], v4, s[44:47], 0 offen offset:768
    buffer_store_dwordx4 v[144:147], v4, s[44:47], 0 offen offset:1024
    buffer_store_dwordx4 v[148:151], v4, s[44:47], 0 offen offset:1280
    buffer_store_dwordx4 v[152:155], v4, s[44:47], 0 offen offset:1536
    buffer_store_dwordx4 v[156:159], v4, s[44:47], 0 offen offset:1792
k3_end:
    s_endpgm
.globl k4_kernel
.p2align 8
.type k4_kernel,@function
k4_kernel:
    s_cmp_ge_u32 s2, 64
    s_cbranch_scc1 k4_end
    s_load_dwordx16 s[16:31], s[0:1], 0
    s_load_dwordx8 s[32:39], s[0:1], 64
    s_load_dwordx2 s[40:41], s[0:1], 96
    v_lshrrev_b32 v3, 6, v0
    v_and_b32 v1, 63, v0
    v_readfirstlane_b32 s3, v3
    v_and_b32 v2, 15, v1
    v_lshrrev_b32 v3, 4, v1
    s_mov_b32 s14, 0x05040100
    s_mov_b32 s15, 0x07060302
    s_waitcnt lgkmcnt(0)
    s_add_u32 s44, s40, 0x600000
    s_addc_u32 s45, s41, 0
    s_and_b32 s45, s45, 0xffff
    s_mov_b32 s46, 0x100000
    s_mov_b32 s47, 0x20000
    s_add_u32 s48, s40, 0x700000
    s_addc_u32 s49, s41, 0
    s_and_b32 s49, s49, 0xffff
    s_mov_b32 s50, 0x70000
    s_mov_b32 s51, 0x20000
    s_mov_b32 s52, s16
    s_and_b32 s53, s17, 0xffff
    s_mov_b32 s54, 0x1000
    s_mov_b32 s55, 0x20000
    s_mov_b32 s56, s36
    s_and_b32 s57, s37, 0xffff
    s_mov_b32 s58, 0x1000
    s_mov_b32 s59, 0x20000
    s_mov_b32 s13, 8192
    s_mov_b32 s12, 16384
    s_mov_b32 s11, 24576
    v_and_b32 v4, 7, v0
    v_lshrrev_b32 v5, 3, v0
    s_lshl_b32 s10, s2, 7
    v_lshlrev_b32 v6, 4, v4
    v_add_u32 v6, s10, v6
    v_lshlrev_b32 v7, 15, v5
    v_add_u32 v7, v7, v6
    buffer_load_dwordx4 v[16:19], v7, s[44:47], 0 offen
    buffer_load_dwordx4 v[20:23], v7, s[44:47], s13 offen
    buffer_load_dwordx4 v[24:27], v7, s[44:47], s12 offen
    buffer_load_dwordx4 v[28:31], v7, s[44:47], s11 offen
    v_lshlrev_b32 v7, 14, v5
    v_add_u32 v7, v7, v6
    buffer_load_dwordx4 v[32:35], v7, s[48:51], 0 offen
    buffer_load_dwordx4 v[36:39], v7, s[48:51], s13 offen
    v_lshrrev_b32 v8, 2, v0
    s_lshl_b32 s10, s2, 3
    v_add_u32 v8, s10, v8
    v_and_b32 v9, 15, v8
    v_lshrrev_b32 v10, 4, v8
    v_and_b32 v10, 7, v10
    v_lshrrev_b32 v11, 7, v8
    v_lshlrev_b32 v11, 7, v11
    v_lshl_add_u32 v11, v9, 3, v11
    v_add_u32 v11, v11, v10
    v_and_b32 v12, 3, v0
    v_lshl_add_u32 v11, v12, 9, v11
    v_lshlrev_b32 v11, 1, v11
    buffer_load_ushort v13, v11, s[52:55], 0 offen
    s_waitcnt vmcnt(1)
    v_add_f32 v16, v16, v20
    v_add_f32 v24, v24, v28
    v_add_f32 v20, v32, v36
    v_add_f32 v17, v17, v21
    v_add_f32 v25, v25, v29
    v_add_f32 v21, v33, v37
    v_add_f32 v18, v18, v22
    v_add_f32 v26, v26, v30
    v_add_f32 v22, v34, v38
    v_add_f32 v19, v19, v23
    v_add_f32 v27, v27, v31
    v_add_f32 v23, v35, v39
    v_add_f32 v16, v16, v24
    v_add_f32 v17, v17, v25
    v_add_f32 v18, v18, v26
    v_add_f32 v19, v19, v27
    s_nop 1
    v_add_f32_dpp v24, v16, v16 row_ror:8 row_mask:0xf bank_mask:0xf
    v_add_f32_dpp v25, v17, v17 row_ror:8 row_mask:0xf bank_mask:0xf
    v_add_f32_dpp v26, v18, v18 row_ror:8 row_mask:0xf bank_mask:0xf
    v_add_f32_dpp v27, v19, v19 row_ror:8 row_mask:0xf bank_mask:0xf
    v_add_f32_dpp v28, v20, v20 row_ror:8 row_mask:0xf bank_mask:0xf
    v_add_f32_dpp v29, v21, v21 row_ror:8 row_mask:0xf bank_mask:0xf
    v_add_f32_dpp v30, v22, v22 row_ror:8 row_mask:0xf bank_mask:0xf
    v_add_f32_dpp v31, v23, v23 row_ror:8 row_mask:0xf bank_mask:0xf
    v_mov_b32 v16, v24
    v_mov_b32 v17, v25
    v_mov_b32 v18, v26
    v_mov_b32 v19, v27
    v_mov_b32 v20, v28
    v_mov_b32 v21, v29
    v_mov_b32 v22, v30
    v_mov_b32 v23, v31
    s_nop 1
    v_permlane16_swap_b32 v16, v24
    v_permlane16_swap_b32 v17, v25
    v_permlane16_swap_b32 v18, v26
    v_permlane16_swap_b32 v19, v27
    v_permlane16_swap_b32 v20, v28
    v_permlane16_swap_b32 v21, v29
    v_permlane16_swap_b32 v22, v30
    v_permlane16_swap_b32 v23, v31
    s_nop 0
    v_add_f32 v16, v16, v24
    v_add_f32 v17, v17, v25
    v_add_f32 v18, v18, v26
    v_add_f32 v19, v19, v27
    v_add_f32 v20, v20, v28
    v_add_f32 v21, v21, v29
    v_add_f32 v22, v22, v30
    v_add_f32 v23, v23, v31
    v_mov_b32 v24, v16
    v_mov_b32 v25, v17
    v_mov_b32 v26, v18
    v_mov_b32 v27, v19
    v_mov_b32 v28, v20
    v_mov_b32 v29, v21
    v_mov_b32 v30, v22
    v_mov_b32 v31, v23
    s_nop 1
    v_permlane32_swap_b32 v16, v24
    v_permlane32_swap_b32 v17, v25
    v_permlane32_swap_b32 v18, v26
    v_permlane32_swap_b32 v19, v27
    v_permlane32_swap_b32 v20, v28
    v_permlane32_swap_b32 v21, v29
    v_permlane32_swap_b32 v22, v30
    v_permlane32_swap_b32 v23, v31
    s_nop 0
    v_add_f32 v16, v16, v24
    v_add_f32 v17, v17, v25
    v_add_f32 v18, v18, v26
    v_add_f32 v19, v19, v27
    v_add_f32 v20, v20, v28
    v_add_f32 v21, v21, v29
    v_add_f32 v22, v22, v30
    v_add_f32 v23, v23, v31
    s_lshl_b32 s10, s3, 8
    v_lshlrev_b32 v14, 5, v4
    v_add_u32 v14, s10, v14
    s_mov_b64 exec, 0xff
    ds_write_b128 v14, v[16:19]
    ds_write_b128 v14, v[20:23] offset:16
    s_mov_b64 exec, -1
    s_waitcnt lgkmcnt(0)
    s_barrier
    s_cmp_lg_u32 s3, 0
    s_cbranch_scc1 k4_end
    s_mov_b32 exec_lo, -1
    s_mov_b32 exec_hi, 0
    v_lshrrev_b32 v14, 2, v0
    v_lshlrev_b32 v14, 5, v14
    v_lshl_add_u32 v14, v12, 2, v14
    ds_read_b32 v16, v14 offset:0
    ds_read_b32 v20, v14 offset:16
    ds_read_b32 v17, v14 offset:256
    ds_read_b32 v21, v14 offset:272
    ds_read_b32 v18, v14 offset:512
    ds_read_b32 v22, v14 offset:528
    ds_read_b32 v19, v14 offset:768
    ds_read_b32 v23, v14 offset:784
    s_waitcnt vmcnt(0) lgkmcnt(0)
    v_add_f32 v16, v16, v17
    v_add_f32 v18, v18, v19
    v_add_f32 v20, v20, v21
    v_add_f32 v22, v22, v23
    v_add_f32 v16, v16, v18
    v_add_f32 v20, v20, v22
    v_cvt_pk_bf16_f32 v24, v16, v20
    v_lshlrev_b32 v16, 16, v24
    v_and_b32 v20, 0xffff0000, v24
    v_mul_f32 v25, 0xbfb8aa3b, v20
    v_exp_f32 v25, v25
    s_nop 0
    v_add_f32 v25, 1.0, v25
    v_rcp_f32 v25, v25
    s_nop 0
    v_mul_f32 v20, v20, v25
    v_cvt_pk_bf16_f32 v24, v20, v20
    v_lshlrev_b32 v20, 16, v24
    v_mul_f32 v16, v16, v20
    v_cvt_pk_bf16_f32 v24, v16, v16
    v_lshlrev_b32 v16, 16, v24
    v_lshlrev_b32 v13, 16, v13
    v_add_f32 v16, v16, v13
    v_cvt_pk_bf16_f32 v24, v16, v16
    buffer_store_short v24, v11, s[56:59], 0 offen
k4_end:
    s_endpgm
.section .rodata,"a"
.p2align 6
.amdhsa_kernel k1_kernel
  .amdhsa_next_free_vgpr 240
  .amdhsa_next_free_sgpr 102
  .amdhsa_accum_offset 240
  .amdhsa_group_segment_fixed_size 0
  .amdhsa_kernarg_size 104
  .amdhsa_user_sgpr_count 2
  .amdhsa_user_sgpr_kernarg_segment_ptr 1
  .amdhsa_system_sgpr_workgroup_id_x 1
.end_amdhsa_kernel
.p2align 6
.amdhsa_kernel k2_kernel
  .amdhsa_next_free_vgpr 216
  .amdhsa_next_free_sgpr 102
  .amdhsa_accum_offset 216
  .amdhsa_group_segment_fixed_size 0
  .amdhsa_kernarg_size 104
  .amdhsa_user_sgpr_count 2
  .amdhsa_user_sgpr_kernarg_segment_ptr 1
  .amdhsa_system_sgpr_workgroup_id_x 1
.end_amdhsa_kernel
.p2align 6
.amdhsa_kernel k3_kernel
  .amdhsa_next_free_vgpr 256
  .amdhsa_next_free_sgpr 102
  .amdhsa_accum_offset 256
  .amdhsa_group_segment_fixed_size 0
  .amdhsa_kernarg_size 104
  .amdhsa_user_sgpr_count 2
  .amdhsa_user_sgpr_kernarg_segment_ptr 1
  .amdhsa_system_sgpr_workgroup_id_x 1
.end_amdhsa_kernel
.p2align 6
.amdhsa_kernel k4_kernel
  .amdhsa_next_free_vgpr 40
  .amdhsa_next_free_sgpr 102
  .amdhsa_accum_offset 40
  .amdhsa_group_segment_fixed_size 0
  .amdhsa_kernarg_size 104
  .amdhsa_user_sgpr_count 2
  .amdhsa_user_sgpr_kernarg_segment_ptr 1
  .amdhsa_system_sgpr_workgroup_id_x 1
.end_amdhsa_kernel
```
